```python
import torch

def _softmax(x, axis=-1):
    return torch.softmax(x, dim=axis)
def _gelu(x):
    return torch.nn.functional.gelu(x, approximate="tanh")
def _silu(x):
    return torch.nn.functional.silu(x)
def _sigmoid(x):
    return torch.sigmoid(x)
def _layernorm(x, axis=-1, eps=1e-5):
    m = x.mean(dim=axis, keepdim=True)
    v = x.var(dim=axis, keepdim=True, unbiased=False)
    return (x - m) / torch.sqrt(v + eps)
def _scatter_add(tgt, idx, src, axis=0):
    return tgt.clone().index_add_(axis, idx, src)
def _segment_sum(src, seg, n):
    out = torch.zeros((n,) + src.shape[1:], dtype=src.dtype)
    return out.index_add_(0, seg, src)
def _pad(x, pw):
    flat = tuple(v for pair in reversed(pw) for v in pair)
    return torch.nn.functional.pad(x, flat)

kernel_name = 'parallel_sum__linear_attn_block__dense_activation_squared_relu__prompt'

def setup_inputs():

    _w = (lambda a: (lambda t: t.to(torch.bfloat16) if t.is_floating_point() else t)(torch.as_tensor(a)))
    def _A_setup():
        B, S, D = 1, 2048, 448
        return {
            "x": _w((lambda *s: torch.randn(*s, dtype=torch.bfloat16) * 0.05)(B, S, D)),
            "wqkv": _w((lambda *s: torch.randn(*s, dtype=torch.bfloat16) * 0.4)(D, 3 * D)),
            "wo": _w((lambda *s: torch.randn(*s, dtype=torch.bfloat16) * 0.4)(D, D)),
        }
    _A_in = _A_setup()

    def _B_setup():
        B, S, D, F = 1, 2048, 448, 1792
        return {
            "x": _w((lambda *s: torch.randn(*s, dtype=torch.bfloat16) * 0.05)(B, S, D)),
            "w1": _w((lambda *s: torch.randn(*s, dtype=torch.bfloat16) * 0.05)(D, F)),
            "b1": _w((lambda *s: torch.randn(*s, dtype=torch.bfloat16) * 0.4)(F)),
            "w2": _w((lambda *s: torch.randn(*s, dtype=torch.bfloat16) * 0.05)(F, D)),
            "b2": _w((lambda *s: torch.randn(*s, dtype=torch.bfloat16) * 1.6)(D)),
        }
    _B_in = _B_setup()

    return {
        "A_x": _A_in["x"],
        "A_wqkv": _A_in["wqkv"],
        "A_wo": _A_in["wo"],
        "B_x": _B_in["x"],
        "B_w1": _B_in["w1"],
        "B_b1": _B_in["b1"],
        "B_w2": _B_in["w2"],
        "B_b2": _B_in["b2"],
    }

def reference(A_x, A_wqkv, A_wo, B_x, B_w1, B_b1, B_w2, B_b2):
    def _A_ref(x, wqkv, wo):
        B, S, D = x.shape
        H = 16; Dh = D // H
        qkv = (lambda x, *d: x.permute(*d))((x @ wqkv).reshape(B, S, 3, H, Dh), 2, 0, 3, 1, 4)
        q, k, v = qkv[0], qkv[1], qkv[2]
        phi = lambda t: torch.where(t > 0, t + 1, torch.exp(t)) + 1e-6
        pq, pk = phi(q), phi(k)
        kv = torch.einsum("bhsd,bhse->bhde", pk, v)
        z = torch.einsum("bhsd->bhd", pk)
        num = torch.einsum("bhqd,bhde->bhqe", pq, kv)
        den = torch.einsum("bhqd,bhd->bhq", pq, z)[..., None] + 1e-6
        o = num / den
        return (lambda x, *d: x.permute(*d))(o, 0, 2, 1, 3).reshape(B, S, D) @ wo

    def _B_ref(x, w1, b1, w2, b2):
        h = torch.einsum("bsd,df->bsf", x, w1) + b1
        zero = torch.zeros_like(h)
        r = torch.where(h > zero, h, zero)
        h = r * r
        out = torch.einsum("bsf,fd->bsd", h, w2) + b2
        return out

    x = A_x
    xn = _layernorm(x, axis=-1)
    return x + _A_ref(xn, A_wqkv, A_wo) + _B_ref(xn, B_w1, B_b1, B_w2, B_b2)
```

```asm
; @launch grid=(256,1,1) block=(512,1,1) lds=163840
.amdgcn_target "amdgcn-amd-amdhsa--gfx950"
.text
.globl parallel_sum__linear_attn_block__dense_activation_squared_relu__prompt_kernel
.p2align 8
.type parallel_sum__linear_attn_block__dense_activation_squared_relu__prompt_kernel,@function
parallel_sum__linear_attn_block__dense_activation_squared_relu__prompt_kernel:
    s_cmp_ge_u32 s2, 256
    s_cbranch_scc1 L_end
    s_load_dwordx16 s[4:19], s[0:1], 0
    s_load_dwordx4 s[20:23], s[0:1], 64
    s_load_dwordx2 s[24:25], s[0:1], 80
    s_getpc_b64 s[98:99]
L_pc:
    s_lshr_b32 s71, s2, 3
    s_lshl_b32 s3, s71, 7
    v_lshrrev_b32 v1, 5, v0
    v_lshl_add_u32 v1, v1, 12, s3
    v_min_u32 v1, L_last - L_pc, v1
    global_load_dword v19, v1, s[98:99]
    v_lshrrev_b32 v1, 6, v0
    v_and_b32 v0, 63, v0
    v_readfirstlane_b32 s99, v1
    s_and_b32 s72, s71, 3
    s_lshr_b32 s68, s71, 2
    s_and_b32 s65, s2, 3
    s_lshl2_add_u32 s65, s65, s72
    s_lshl1_add_u32 s75, s72, s68
    s_cmp_ge_u32 s75, 7
    s_cselect_b32 s70, 7, 0
    s_sub_u32 s75, s75, s70
    s_and_b32 s70, s2, 1
    s_add_u32 s75, s75, s70
    s_cmp_eq_u32 s75, 7
    s_cselect_b32 s75, 0, s75
    s_and_b32 s3, s99, 3
    s_mul_i32 s26, s3, 40960
    v_lshrrev_b32 v6, 3, v0
    v_and_b32 v7, 7, v0
    v_lshlrev_b32 v18, 4, v0
    s_cmp_ge_u32 s99, 4
    s_cbranch_scc1 L_B
    s_lshl2_add_u32 s73, s65, s3
    s_mul_i32 s61, s73, 28672
    s_lshl_b32 s84, s75, 7
    v_lshrrev_b32 v8, 1, v6
    v_xor_b32 v8, v7, v8
    v_lshlrev_b32 v8, 4, v8
    v_xor_b32 v9, 64, v8
    v_mul_u32_u24 v10, 896, v6
    v_add_u32 v1, v10, v8
    v_add_u32 v9, v10, v9
    v_add_u32 v2, 6144, v9
    v_add_u32 v3, 12288, v1
    v_add_u32 v4, 18432, v9
    s_mov_b32 s30, 1835008
    s_mov_b32 s31, 0x20000
    s_add_u32 s75, s75, 1
    s_cmp_eq_u32 s75, 7
    s_cselect_b32 s75, 0, s75
    s_lshl_b32 s85, s75, 7
    s_add_u32 s75, s75, 1
    s_cmp_eq_u32 s75, 7
    s_cselect_b32 s75, 0, s75
    s_lshl_b32 s86, s75, 7
    s_add_u32 m0, s26, 0
    s_add_u32 s27, s61, s84
    s_waitcnt lgkmcnt(0)
    s_mov_b32 s28, s4
    s_mov_b32 s29, s5
    buffer_load_dwordx4 v1, s[28:31], s27 offen offset:0 lds
    buffer_load_dwordx4 v2, s[28:31], s27 offen offset:1024 lds
    buffer_load_dwordx4 v3, s[28:31], s27 offen offset:2048 lds
    buffer_load_dwordx4 v4, s[28:31], s27 offen offset:3072 lds
    s_addk_i32 m0, 4096
    s_add_u32 s27, s61, s85
    buffer_load_dwordx4 v1, s[28:31], s27 offen offset:0 lds
    buffer_load_dwordx4 v2, s[28:31], s27 offen offset:1024 lds
    buffer_load_dwordx4 v3, s[28:31], s27 offen offset:2048 lds
    buffer_load_dwordx4 v4, s[28:31], s27 offen offset:3072 lds
    s_addk_i32 m0, 4096
    s_add_u32 s27, s61, s86
    buffer_load_dwordx4 v1, s[28:31], s27 offen offset:0 lds
    buffer_load_dwordx4 v2, s[28:31], s27 offen offset:1024 lds
    buffer_load_dwordx4 v3, s[28:31], s27 offen offset:2048 lds
    buffer_load_dwordx4 v4, s[28:31], s27 offen offset:3072 lds
    s_add_u32 s75, s75, 1
    s_cmp_eq_u32 s75, 7
    s_cselect_b32 s75, 0, s75
    s_lshl_b32 s87, s75, 7
    s_add_u32 s75, s75, 1
    s_cmp_eq_u32 s75, 7
    s_cselect_b32 s75, 0, s75
    s_lshl_b32 s88, s75, 7
    s_add_u32 s75, s75, 1
    s_cmp_eq_u32 s75, 7
    s_cselect_b32 s75, 0, s75
    s_lshl_b32 s89, s75, 7
    s_add_u32 s75, s75, 1
    s_cmp_eq_u32 s75, 7
    s_cselect_b32 s75, 0, s75
    s_lshl_b32 s90, s75, 7
    s_addk_i32 m0, 4096
    s_add_u32 s27, s61, s87
    s_bfe_u32 s70, s2, 0x10002
    s_lshl1_add_u32 s69, s65, s70
    s_and_b32 s66, s68, 3
    s_lshl2_add_u32 s66, s70, s66
    s_lshr_b32 s67, s68, 2
    s_mov_b32 s36, s24
    s_mov_b32 s37, s25
    s_mov_b32 s38, 15728640
    s_mov_b32 s39, 0x20000
    s_mov_b32 s32, s14
    s_mov_b32 s33, s15
    s_mov_b32 s34, 3584
    s_mov_b32 s35, 0x20000
    v_and_b32 v8, 31, v0
    v_lshrrev_b32 v10, 5, v0
    v_bfe_u32 v11, v0, 1, 3
    v_xor_b32 v11, v10, v11
    v_lshlrev_b32 v11, 4, v11
    v_lshl_add_u32 v11, v8, 7, v11
    v_add_u32 v14, s26, v11
    v_xor_b32 v15, 32, v14
    v_xor_b32 v16, 64, v14
    v_xor_b32 v17, 96, v14
    s_mov_b32 vcc_lo, 0xf0f00f0f
    s_mov_b32 vcc_hi, vcc_lo
    v_mov_b32 v11, 0x3f803f80
    v_cndmask_b32 v48, 0, v11, vcc
    v_cndmask_b32 v49, 0, v11, vcc
    v_cndmask_b32 v50, 0, v11, vcc
    v_cndmask_b32 v51, 0, v11, vcc
    s_mov_b32 s40, 0xaaaaaaaa
    s_mov_b32 s41, s40
    s_mov_b32 s42, 0xcccccccc
    s_mov_b32 s43, s42
    s_mov_b32 s44, 0xff00ff00
    s_mov_b32 s45, s44
    s_mov_b32 s46, 0xf0f0f0f0
    s_mov_b32 s47, s46
    s_mov_b32 s10, 0xffff0000
    s_mov_b32 s11, s10
    s_mov_b32 s82, 0
    s_mov_b32 s83, -1
    s_mov_b32 s50, 0x3fb8aa3b
    s_mov_b32 s51, 0x358637bd
    s_mov_b32 s48, 0xf0000000
    s_mov_b32 s49, s48
    s_mov_b32 s62, 15
    s_mov_b32 s63, 15
    s_cmp_eq_u32 s67, 0
    s_cselect_b32 s71, 64, 48
    s_cselect_b64 vcc, -1, 0
    v_bfe_u32 v11, v0, 2, 2
    v_and_b32 v12, 3, v0
    v_lshlrev_b32 v12, 3, v12
    v_bfe_u32 v13, v0, 4, 1
    v_lshl_add_u32 v12, v13, 5, v12
    v_and_b32 v13, 2, v11
    v_lshlrev_b32 v13, 5, v13
    v_lshl_add_u32 v9, v10, 3, v11
    v_lshl_add_u32 v7, v9, 6, v12
    v_lshlrev_b32 v9, 7, v9
    v_xor_b32 v8, v12, v13
    v_add_u32 v20, v9, v8
    v_xor_b32 v8, 64, v20
    v_cndmask_b32 v7, v8, v7, vcc
    v_add_u32 v8, s71, v12
    v_xor_b32 v8, v8, v13
    v_add_u32 v24, v9, v8
    v_add_u32 v21, 40960, v20
    v_add_u32 v22, 81920, v20
    v_add_u32 v23, 122880, v20
    v_add_u32 v25, 40960, v24
    v_add_u32 v26, 81920, v24
    v_add_u32 v27, 122880, v24
    v_add_u32 v10, s26, v18
    v_mov_b32 v8, 1
    s_lshl3_add_u32 s70, s65, s66
    s_lshl_b32 s70, s70, 7
    s_lshl2_add_u32 s70, s3, s70
    s_lshl_b32 s71, s73, 7
    s_lshl2_add_u32 s71, s66, s71
    s_add_u32 s71, s71, 16384
    s_cmp_eq_u32 s67, 0
    s_cselect_b32 s70, s70, s71
    s_add_u32 s70, s70, 12058624
    v_mov_b32 v9, s70
    s_waitcnt vmcnt(8)
    ds_read_b128 v[56:59], v14 offset:0
    ds_read_b128 v[64:67], v15 offset:0
    s_waitcnt lgkmcnt(1)
    v_mfma_f32_32x32x16_bf16 v[28:43], v[56:59], v[56:59], 0
    ds_read_b128 v[72:75], v16 offset:0
    buffer_load_dwordx4 v1, s[28:31], s27 offen offset:0 lds
    v_lshlrev_b32 v52, 16, v56
    v_and_b32 v53, s10, v56
    v_lshlrev_b32 v54, 16, v57
    v_and_b32 v55, s10, v57
    v_mfma_f32_16x16x32_bf16 v[44:47], v[48:51], v[56:59], 0
    v_lshlrev_b32 v56, 16, v58
    v_and_b32 v57, s10, v58
    v_lshlrev_b32 v58, 16, v59
    v_and_b32 v59, s10, v59
    s_lshl4_add_u32 s70, s66, s65
    s_waitcnt lgkmcnt(1)
    v_mfma_f32_32x32x16_bf16 v[28:43], v[64:67], v[64:67], v[28:43]
    ds_read_b128 v[80:83], v17 offset:0
    buffer_load_dwordx4 v2, s[28:31], s27 offen offset:1024 lds
    v_lshlrev_b32 v60, 16, v64
    v_and_b32 v61, s10, v64
    v_lshlrev_b32 v62, 16, v65
    v_and_b32 v63, s10, v65
    v_mfma_f32_16x16x32_bf16 v[44:47], v[48:51], v[64:67], v[44:47]
    v_lshlrev_b32 v64, 16, v66
    v_and_b32 v65, s10, v66
    v_lshlrev_b32 v66, 16, v67
    v_and_b32 v67, s10, v67
    s_lshl_b32 s70, s70, 7
    s_waitcnt lgkmcnt(1)
    v_mfma_f32_32x32x16_bf16 v[28:43], v[72:75], v[72:75], v[28:43]
    s_waitcnt vmcnt(6)
    ds_read_b128 v[88:91], v14 offset:4096
    buffer_load_dwordx4 v3, s[28:31], s27 offen offset:2048 lds
    v_lshlrev_b32 v68, 16, v72
    v_and_b32 v69, s10, v72
    v_lshlrev_b32 v70, 16, v73
    v_and_b32 v71, s10, v73
    v_mfma_f32_16x16x32_bf16 v[44:47], v[48:51], v[72:75], v[44:47]
    v_lshlrev_b32 v72, 16, v74
    v_and_b32 v73, s10, v74
    v_lshlrev_b32 v74, 16, v75
    v_and_b32 v75, s10, v75
    s_lshl2_add_u32 s70, s3, s70
    s_waitcnt lgkmcnt(1)
    v_mfma_f32_32x32x16_bf16 v[28:43], v[80:83], v[80:83], v[28:43]
    ds_read_b128 v[96:99], v15 offset:4096
    buffer_load_dwordx4 v4, s[28:31], s27 offen offset:3072 lds
    s_addk_i32 m0, 4096
    s_add_u32 s27, s61, s88
    v_lshlrev_b32 v76, 16, v80
    v_and_b32 v77, s10, v80
    v_lshlrev_b32 v78, 16, v81
    v_and_b32 v79, s10, v81
    v_mfma_f32_16x16x32_bf16 v[44:47], v[48:51], v[80:83], v[44:47]
    v_lshlrev_b32 v80, 16, v82
    v_and_b32 v81, s10, v82
    v_lshlrev_b32 v82, 16, v83
    v_and_b32 v83, s10, v83
    s_add_u32 s70, s70, 12091392
    s_waitcnt lgkmcnt(1)
    v_mfma_f32_32x32x16_bf16 v[28:43], v[88:91], v[88:91], v[28:43]
    ds_read_b128 v[104:107], v16 offset:4096
    buffer_load_dwordx4 v1, s[28:31], s27 offen offset:0 lds
    v_lshlrev_b32 v84, 16, v88
    v_and_b32 v85, s10, v88
    v_lshlrev_b32 v86, 16, v89
    v_and_b32 v87, s10, v89
    v_mfma_f32_16x16x32_bf16 v[44:47], v[48:51], v[88:91], v[44:47]
    v_lshlrev_b32 v88, 16, v90
    v_and_b32 v89, s10, v90
    v_lshlrev_b32 v90, 16, v91
    v_and_b32 v91, s10, v91
    v_mov_b32 v13, s70
    s_waitcnt lgkmcnt(1)
    v_mfma_f32_32x32x16_bf16 v[28:43], v[96:99], v[96:99], v[28:43]
    ds_read_b128 v[112:115], v17 offset:4096
    buffer_load_dwordx4 v2, s[28:31], s27 offen offset:1024 lds
    v_lshlrev_b32 v92, 16, v96
    v_and_b32 v93, s10, v96
    v_lshlrev_b32 v94, 16, v97
    v_and_b32 v95, s10, v97
    v_mfma_f32_16x16x32_bf16 v[44:47], v[48:51], v[96:99], v[44:47]
    v_lshlrev_b32 v96, 16, v98
    v_and_b32 v97, s10, v98
    v_lshlrev_b32 v98, 16, v99
    v_and_b32 v99, s10, v99
    s_lshl2_add_u32 s70, s66, s3
    s_waitcnt lgkmcnt(1)
    v_mfma_f32_32x32x16_bf16 v[28:43], v[104:107], v[104:107], v[28:43]
    s_waitcnt vmcnt(6)
    ds_read_b128 v[120:123], v14 offset:8192
    buffer_load_dwordx4 v3, s[28:31], s27 offen offset:2048 lds
    v_lshlrev_b32 v100, 16, v104
    v_and_b32 v101, s10, v104
    v_lshlrev_b32 v102, 16, v105
    v_and_b32 v103, s10, v105
    v_mfma_f32_16x16x32_bf16 v[44:47], v[48:51], v[104:107], v[44:47]
    v_lshlrev_b32 v104, 16, v106
    v_and_b32 v105, s10, v106
    v_lshlrev_b32 v106, 16, v107
    v_and_b32 v107, s10, v107
    s_lshl4_add_u32 s70, s70, s65
    s_waitcnt lgkmcnt(1)
    v_mfma_f32_32x32x16_bf16 v[28:43], v[112:115], v[112:115], v[28:43]
    ds_read_b128 v[128:131], v15 offset:8192
    buffer_load_dwordx4 v4, s[28:31], s27 offen offset:3072 lds
    s_addk_i32 m0, 4096
    s_add_u32 s27, s61, s89
    v_lshlrev_b32 v108, 16, v112
    v_and_b32 v109, s10, v112
    v_lshlrev_b32 v110, 16, v113
    v_and_b32 v111, s10, v113
    v_mfma_f32_16x16x32_bf16 v[44:47], v[48:51], v[112:115], v[44:47]
    v_lshlrev_b32 v112, 16, v114
    v_and_b32 v113, s10, v114
    v_lshlrev_b32 v114, 16, v115
    v_and_b32 v115, s10, v115
    s_lshl_b32 s70, s70, 10
    s_waitcnt lgkmcnt(1)
    v_mfma_f32_32x32x16_bf16 v[28:43], v[120:123], v[120:123], v[28:43]
    ds_read_b128 v[136:139], v16 offset:8192
    buffer_load_dwordx4 v1, s[28:31], s27 offen offset:0 lds
    v_lshlrev_b32 v116, 16, v120
    v_and_b32 v117, s10, v120
    v_lshlrev_b32 v118, 16, v121
    v_and_b32 v119, s10, v121
    v_mfma_f32_16x16x32_bf16 v[44:47], v[48:51], v[120:123], v[44:47]
    v_lshlrev_b32 v120, 16, v122
    v_and_b32 v121, s10, v122
    v_lshlrev_b32 v122, 16, v123
    v_and_b32 v123, s10, v123
    s_add_u32 s52, s70, 11534336
    s_waitcnt lgkmcnt(1)
    v_mfma_f32_32x32x16_bf16 v[28:43], v[128:131], v[128:131], v[28:43]
    ds_read_b128 v[144:147], v17 offset:8192
    buffer_load_dwordx4 v2, s[28:31], s27 offen offset:1024 lds
    v_lshlrev_b32 v124, 16, v128
    v_and_b32 v125, s10, v128
    v_lshlrev_b32 v126, 16, v129
    v_and_b32 v127, s10, v129
    v_mfma_f32_16x16x32_bf16 v[44:47], v[48:51], v[128:131], v[44:47]
    v_lshlrev_b32 v128, 16, v130
    v_and_b32 v129, s10, v130
    v_lshlrev_b32 v130, 16, v131
    v_and_b32 v131, s10, v131
    s_mul_i32 s53, s73, 35
    s_waitcnt lgkmcnt(1)
    v_mfma_f32_32x32x16_bf16 v[28:43], v[136:139], v[136:139], v[28:43]
    s_waitcnt vmcnt(6)
    ds_read_b128 v[152:155], v14 offset:12288
    buffer_load_dwordx4 v3, s[28:31], s27 offen offset:2048 lds
    v_lshlrev_b32 v132, 16, v136
    v_and_b32 v133, s10, v136
    v_lshlrev_b32 v134, 16, v137
    v_and_b32 v135, s10, v137
    v_mfma_f32_16x16x32_bf16 v[44:47], v[48:51], v[136:139], v[44:47]
    v_lshlrev_b32 v136, 16, v138
    v_and_b32 v137, s10, v138
    v_lshlrev_b32 v138, 16, v139
    v_and_b32 v139, s10, v139
    s_lshl1_add_u32 s57, s53, s66
    s_waitcnt lgkmcnt(1)
    v_mfma_f32_32x32x16_bf16 v[28:43], v[144:147], v[144:147], v[28:43]
    ds_read_b128 v[160:163], v15 offset:12288
    buffer_load_dwordx4 v4, s[28:31], s27 offen offset:3072 lds
    s_addk_i32 m0, 4096
    s_add_u32 s27, s61, s90
    v_lshlrev_b32 v140, 16, v144
    v_and_b32 v141, s10, v144
    v_lshlrev_b32 v142, 16, v145
    v_and_b32 v143, s10, v145
    v_mfma_f32_16x16x32_bf16 v[44:47], v[48:51], v[144:147], v[44:47]
    v_lshlrev_b32 v144, 16, v146
    v_and_b32 v145, s10, v146
    v_lshlrev_b32 v146, 16, v147
    v_and_b32 v147, s10, v147
    s_add_u32 s53, s53, s66
    s_waitcnt lgkmcnt(1)
    v_mfma_f32_32x32x16_bf16 v[28:43], v[152:155], v[152:155], v[28:43]
    ds_read_b128 v[168:171], v16 offset:12288
    buffer_load_dwordx4 v1, s[28:31], s27 offen offset:0 lds
    v_lshlrev_b32 v148, 16, v152
    v_and_b32 v149, s10, v152
    v_lshlrev_b32 v150, 16, v153
    v_and_b32 v151, s10, v153
    v_mfma_f32_16x16x32_bf16 v[44:47], v[48:51], v[152:155], v[44:47]
    v_lshlrev_b32 v152, 16, v154
    v_and_b32 v153, s10, v154
    v_lshlrev_b32 v154, 16, v155
    v_and_b32 v155, s10, v155
    s_lshl_b32 s53, s53, 12
    s_waitcnt lgkmcnt(1)
    v_mfma_f32_32x32x16_bf16 v[28:43], v[160:163], v[160:163], v[28:43]
    ds_read_b128 v[176:179], v17 offset:12288
    buffer_load_dwordx4 v2, s[28:31], s27 offen offset:1024 lds
    v_lshlrev_b32 v156, 16, v160
    v_and_b32 v157, s10, v160
    v_lshlrev_b32 v158, 16, v161
    v_and_b32 v159, s10, v161
    v_mfma_f32_16x16x32_bf16 v[44:47], v[48:51], v[160:163], v[44:47]
    v_lshlrev_b32 v160, 16, v162
    v_and_b32 v161, s10, v162
    v_lshlrev_b32 v162, 16, v163
    v_and_b32 v163, s10, v163
    s_add_u32 s57, s57, 48
    s_waitcnt lgkmcnt(1)
    v_mfma_f32_32x32x16_bf16 v[28:43], v[168:171], v[168:171], v[28:43]
    s_waitcnt vmcnt(6)
    ds_read_b128 v[184:187], v14 offset:16384
    buffer_load_dwordx4 v3, s[28:31], s27 offen offset:2048 lds
    v_lshlrev_b32 v164, 16, v168
    v_and_b32 v165, s10, v168
    v_lshlrev_b32 v166, 16, v169
    v_and_b32 v167, s10, v169
    v_mfma_f32_16x16x32_bf16 v[44:47], v[48:51], v[168:171], v[44:47]
    v_lshlrev_b32 v168, 16, v170
    v_and_b32 v169, s10, v170
    v_lshlrev_b32 v170, 16, v171
    v_and_b32 v171, s10, v171
    s_lshl_b32 s57, s57, 11
    s_waitcnt lgkmcnt(1)
    v_mfma_f32_32x32x16_bf16 v[28:43], v[176:179], v[176:179], v[28:43]
    ds_read_b128 v[192:195], v15 offset:16384
    buffer_load_dwordx4 v4, s[28:31], s27 offen offset:3072 lds
    v_lshlrev_b32 v172, 16, v176
    v_and_b32 v173, s10, v176
    v_lshlrev_b32 v174, 16, v177
    v_and_b32 v175, s10, v177
    v_mfma_f32_16x16x32_bf16 v[44:47], v[48:51], v[176:179], v[44:47]
    v_lshlrev_b32 v176, 16, v178
    v_and_b32 v177, s10, v178
    v_lshlrev_b32 v178, 16, v179
    v_and_b32 v179, s10, v179
    s_mul_i32 s54, s73, 7
    s_waitcnt lgkmcnt(1)
    v_mfma_f32_32x32x16_bf16 v[28:43], v[184:187], v[184:187], v[28:43]
    ds_read_b128 v[200:203], v16 offset:16384
    v_lshlrev_b32 v180, 16, v184
    v_and_b32 v181, s10, v184
    v_lshlrev_b32 v182, 16, v185
    v_and_b32 v183, s10, v185
    v_mfma_f32_16x16x32_bf16 v[44:47], v[48:51], v[184:187], v[44:47]
    v_lshlrev_b32 v184, 16, v186
    v_and_b32 v185, s10, v186
    v_lshlrev_b32 v186, 16, v187
    v_and_b32 v187, s10, v187
    s_add_u32 s54, s54, s66
    s_barrier
    s_waitcnt lgkmcnt(1)
    v_mfma_f32_32x32x16_bf16 v[28:43], v[192:195], v[192:195], v[28:43]
    ds_read_b128 v[208:211], v17 offset:16384
    v_lshlrev_b32 v188, 16, v192
    v_and_b32 v189, s10, v192
    v_lshlrev_b32 v190, 16, v193
    v_and_b32 v191, s10, v193
    v_mfma_f32_16x16x32_bf16 v[44:47], v[48:51], v[192:195], v[44:47]
    v_lshlrev_b32 v192, 16, v194
    v_and_b32 v193, s10, v194
    v_lshlrev_b32 v194, 16, v195
    v_and_b32 v195, s10, v195
    s_lshl_b32 s54, s54, 12
    s_waitcnt lgkmcnt(1)
    v_mfma_f32_32x32x16_bf16 v[28:43], v[200:203], v[200:203], v[28:43]
    s_waitcnt vmcnt(4)
    ds_read_b128 v[216:219], v14 offset:20480
    v_lshlrev_b32 v196, 16, v200
    v_and_b32 v197, s10, v200
    v_lshlrev_b32 v198, 16, v201
    v_and_b32 v199, s10, v201
    v_mfma_f32_16x16x32_bf16 v[44:47], v[48:51], v[200:203], v[44:47]
    v_lshlrev_b32 v200, 16, v202
    v_and_b32 v201, s10, v202
    v_lshlrev_b32 v202, 16, v203
    v_and_b32 v203, s10, v203
    s_add_u32 s54, s54, 9437184
    s_waitcnt lgkmcnt(1)
    v_mfma_f32_32x32x16_bf16 v[28:43], v[208:211], v[208:211], v[28:43]
    ds_read_b128 v[224:227], v15 offset:20480
    v_lshlrev_b32 v204, 16, v208
    v_and_b32 v205, s10, v208
    v_lshlrev_b32 v206, 16, v209
    v_and_b32 v207, s10, v209
    v_mfma_f32_16x16x32_bf16 v[44:47], v[48:51], v[208:211], v[44:47]
    v_lshlrev_b32 v208, 16, v210
    v_and_b32 v209, s10, v210
    v_lshlrev_b32 v210, 16, v211
    v_and_b32 v211, s10, v211
    s_cmp_eq_u32 s66, 7
    s_cselect_b32 s54, 15728640, s54
    s_waitcnt lgkmcnt(1)
    v_mfma_f32_32x32x16_bf16 v[28:43], v[216:219], v[216:219], v[28:43]
    ds_read_b128 v[232:235], v16 offset:20480
    v_lshlrev_b32 v212, 16, v216
    v_and_b32 v213, s10, v216
    v_lshlrev_b32 v214, 16, v217
    v_and_b32 v215, s10, v217
    v_mfma_f32_16x16x32_bf16 v[44:47], v[48:51], v[216:219], v[44:47]
    v_lshlrev_b32 v216, 16, v218
    v_and_b32 v217, s10, v218
    v_lshlrev_b32 v218, 16, v219
    v_and_b32 v219, s10, v219
    s_lshl_b32 s55, s66, 7
    s_waitcnt lgkmcnt(1)
    v_mfma_f32_32x32x16_bf16 v[28:43], v[224:227], v[224:227], v[28:43]
    ds_read_b128 v[236:239], v17 offset:20480
    v_lshlrev_b32 v220, 16, v224
    v_and_b32 v221, s10, v224
    v_lshlrev_b32 v222, 16, v225
    v_and_b32 v223, s10, v225
    v_mfma_f32_16x16x32_bf16 v[44:47], v[48:51], v[224:227], v[44:47]
    v_lshlrev_b32 v224, 16, v226
    v_and_b32 v225, s10, v226
    v_lshlrev_b32 v226, 16, v227
    v_and_b32 v227, s10, v227
    s_lshl_b32 s56, s66, 6
    s_waitcnt lgkmcnt(1)
    v_mfma_f32_32x32x16_bf16 v[28:43], v[232:235], v[232:235], v[28:43]
    s_waitcnt vmcnt(0)
    ds_read_b128 v[240:243], v14 offset:24576
    v_lshlrev_b32 v228, 16, v232
    v_and_b32 v229, s10, v232
    v_lshlrev_b32 v230, 16, v233
    v_and_b32 v231, s10, v233
    v_mfma_f32_16x16x32_bf16 v[44:47], v[48:51], v[232:235], v[44:47]
    v_lshlrev_b32 v232, 16, v234
    v_and_b32 v233, s10, v234
    v_lshlrev_b32 v234, 16, v235
    v_and_b32 v235, s10, v235
    s_waitcnt lgkmcnt(1)
    v_mfma_f32_32x32x16_bf16 v[28:43], v[236:239], v[236:239], v[28:43]
    ds_read_b128 v[244:247], v15 offset:24576
    v_mfma_f32_16x16x32_bf16 v[44:47], v[48:51], v[236:239], v[44:47]
    s_waitcnt lgkmcnt(1)
    v_mfma_f32_32x32x16_bf16 v[28:43], v[240:243], v[240:243], v[28:43]
    ds_read_b128 v[248:251], v16 offset:24576
    v_mfma_f32_16x16x32_bf16 v[44:47], v[48:51], v[240:243], v[44:47]
    s_waitcnt lgkmcnt(1)
    v_mfma_f32_32x32x16_bf16 v[28:43], v[244:247], v[244:247], v[28:43]
    ds_read_b128 v[252:255], v17 offset:24576
    v_mfma_f32_16x16x32_bf16 v[44:47], v[48:51], v[244:247], v[44:47]
    s_waitcnt lgkmcnt(1)
    v_mfma_f32_32x32x16_bf16 v[28:43], v[248:251], v[248:251], v[28:43]
    v_mfma_f32_16x16x32_bf16 v[44:47], v[48:51], v[248:251], v[44:47]
    s_waitcnt lgkmcnt(0)
    v_mfma_f32_32x32x16_bf16 v[28:43], v[252:255], v[252:255], v[28:43]
    v_mfma_f32_16x16x32_bf16 v[44:47], v[48:51], v[252:255], v[44:47]
    v_mov_b32 v14, v7
    v_add_u32 v15, 40960, v7
    v_add_u32 v16, 81920, v7
    v_add_u32 v17, 122880, v7
    s_nop 2
    s_nop 0
    v_mul_f32 v44, 0x3b124925, v44
    s_nop 1
    v_cndmask_b32 v28, v28, v29, s[40:41]
    v_cndmask_b32 v30, v30, v31, s[40:41]
    v_cndmask_b32 v32, v32, v33, s[40:41]
    v_cndmask_b32 v34, v34, v35, s[40:41]
    v_cndmask_b32 v36, v36, v37, s[40:41]
    v_cndmask_b32 v38, v38, v39, s[40:41]
    v_cndmask_b32 v40, v40, v41, s[40:41]
    v_cndmask_b32 v42, v42, v43, s[40:41]
    v_cndmask_b32 v28, v28, v30, s[42:43]
    v_cndmask_b32 v32, v32, v34, s[42:43]
    v_cndmask_b32 v36, v36, v38, s[42:43]
    v_cndmask_b32 v40, v40, v42, s[42:43]
    v_cndmask_b32 v28, v28, v32, s[44:45]
    v_cndmask_b32 v36, v36, v40, s[44:45]
    v_cndmask_b32 v29, v28, v36, s[10:11]
    v_cndmask_b32 v28, v28, v36, s[10:11]
    s_nop 1
    v_permlane32_swap_b32 v29, v28
    v_cndmask_b32 v28, v29, v28, s[46:47]
    v_mul_f32 v28, 0x3b124925, v28
    v_fma_f32 v28, -v44, v44, v28
    v_max_f32 v28, 0, v28
    v_add_f32 v28, 0x3727c5ac, v28
    v_rsq_f32 v2, v28
    s_nop 0
    v_mul_f32_e64 v3, -v44, v2
    v_pk_fma_f32 v[108:109], v[108:109], v[2:3], v[2:3] op_sel:[0,0,1] op_sel_hi:[1,0,1]
    v_pk_fma_f32 v[110:111], v[110:111], v[2:3], v[2:3] op_sel:[0,0,1] op_sel_hi:[1,0,1]
    v_pk_fma_f32 v[112:113], v[112:113], v[2:3], v[2:3] op_sel:[0,0,1] op_sel_hi:[1,0,1]
    v_pk_fma_f32 v[114:115], v[114:115], v[2:3], v[2:3] op_sel:[0,0,1] op_sel_hi:[1,0,1]
    v_cvt_pk_bf16_f32 v115, v114, v115
    v_cvt_pk_bf16_f32 v114, v112, v113
    v_cvt_pk_bf16_f32 v113, v110, v111
    v_cvt_pk_bf16_f32 v112, v108, v109
    v_pk_fma_f32 v[100:101], v[100:101], v[2:3], v[2:3] op_sel:[0,0,1] op_sel_hi:[1,0,1]
    v_pk_fma_f32 v[102:103], v[102:103], v[2:3], v[2:3] op_sel:[0,0,1] op_sel_hi:[1,0,1]
    v_pk_fma_f32 v[104:105], v[104:105], v[2:3], v[2:3] op_sel:[0,0,1] op_sel_hi:[1,0,1]
    v_pk_fma_f32 v[106:107], v[106:107], v[2:3], v[2:3] op_sel:[0,0,1] op_sel_hi:[1,0,1]
    v_cvt_pk_bf16_f32 v111, v106, v107
    v_cvt_pk_bf16_f32 v110, v104, v105
    v_cvt_pk_bf16_f32 v109, v102, v103
    v_cvt_pk_bf16_f32 v108, v100, v101
    v_pk_fma_f32 v[92:93], v[92:93], v[2:3], v[2:3] op_sel:[0,0,1] op_sel_hi:[1,0,1]
    v_pk_fma_f32 v[94:95], v[94:95], v[2:3], v[2:3] op_sel:[0,0,1] op_sel_hi:[1,0,1]
    v_pk_fma_f32 v[96:97], v[96:97], v[2:3], v[2:3] op_sel:[0,0,1] op_sel_hi:[1,0,1]
    v_pk_fma_f32 v[98:99], v[98:99], v[2:3], v[2:3] op_sel:[0,0,1] op_sel_hi:[1,0,1]
    v_cvt_pk_bf16_f32 v107, v98, v99
    v_cvt_pk_bf16_f32 v106, v96, v97
    v_cvt_pk_bf16_f32 v105, v94, v95
    v_cvt_pk_bf16_f32 v104, v92, v93
    v_pk_fma_f32 v[84:85], v[84:85], v[2:3], v[2:3] op_sel:[0,0,1] op_sel_hi:[1,0,1]
    v_pk_fma_f32 v[86:87], v[86:87], v[2:3], v[2:3] op_sel:[0,0,1] op_sel_hi:[1,0,1]
    v_pk_fma_f32 v[88:89], v[88:89], v[2:3], v[2:3] op_sel:[0,0,1] op_sel_hi:[1,0,1]
    v_pk_fma_f32 v[90:91], v[90:91], v[2:3], v[2:3] op_sel:[0,0,1] op_sel_hi:[1,0,1]
    v_cvt_pk_bf16_f32 v103, v90, v91
    v_cvt_pk_bf16_f32 v102, v88, v89
    v_cvt_pk_bf16_f32 v101, v86, v87
    v_cvt_pk_bf16_f32 v100, v84, v85
    v_pk_fma_f32 v[76:77], v[76:77], v[2:3], v[2:3] op_sel:[0,0,1] op_sel_hi:[1,0,1]
    v_pk_fma_f32 v[78:79], v[78:79], v[2:3], v[2:3] op_sel:[0,0,1] op_sel_hi:[1,0,1]
    v_pk_fma_f32 v[80:81], v[80:81], v[2:3], v[2:3] op_sel:[0,0,1] op_sel_hi:[1,0,1]
    v_pk_fma_f32 v[82:83], v[82:83], v[2:3], v[2:3] op_sel:[0,0,1] op_sel_hi:[1,0,1]
    v_cvt_pk_bf16_f32 v99, v82, v83
    v_cvt_pk_bf16_f32 v98, v80, v81
    v_cvt_pk_bf16_f32 v97, v78, v79
    v_cvt_pk_bf16_f32 v96, v76, v77
    v_pk_fma_f32 v[68:69], v[68:69], v[2:3], v[2:3] op_sel:[0,0,1] op_sel_hi:[1,0,1]
    v_pk_fma_f32 v[70:71], v[70:71], v[2:3], v[2:3] op_sel:[0,0,1] op_sel_hi:[1,0,1]
    v_pk_fma_f32 v[72:73], v[72:73], v[2:3], v[2:3] op_sel:[0,0,1] op_sel_hi:[1,0,1]
    v_pk_fma_f32 v[74:75], v[74:75], v[2:3], v[2:3] op_sel:[0,0,1] op_sel_hi:[1,0,1]
    v_cvt_pk_bf16_f32 v95, v74, v75
    v_cvt_pk_bf16_f32 v94, v72, v73
    v_cvt_pk_bf16_f32 v93, v70, v71
    v_cvt_pk_bf16_f32 v92, v68, v69
    v_pk_fma_f32 v[60:61], v[60:61], v[2:3], v[2:3] op_sel:[0,0,1] op_sel_hi:[1,0,1]
    v_pk_fma_f32 v[62:63], v[62:63], v[2:3], v[2:3] op_sel:[0,0,1] op_sel_hi:[1,0,1]
    v_pk_fma_f32 v[64:65], v[64:65], v[2:3], v[2:3] op_sel:[0,0,1] op_sel_hi:[1,0,1]
    v_pk_fma_f32 v[66:67], v[66:67], v[2:3], v[2:3] op_sel:[0,0,1] op_sel_hi:[1,0,1]
    v_cvt_pk_bf16_f32 v91, v66, v67
    v_cvt_pk_bf16_f32 v90, v64, v65
    v_cvt_pk_bf16_f32 v89, v62, v63
    v_cvt_pk_bf16_f32 v88, v60, v61
    v_pk_fma_f32 v[52:53], v[52:53], v[2:3], v[2:3] op_sel:[0,0,1] op_sel_hi:[1,0,1]
    v_pk_fma_f32 v[54:55], v[54:55], v[2:3], v[2:3] op_sel:[0,0,1] op_sel_hi:[1,0,1]
    v_pk_fma_f32 v[56:57], v[56:57], v[2:3], v[2:3] op_sel:[0,0,1] op_sel_hi:[1,0,1]
    v_pk_fma_f32 v[58:59], v[58:59], v[2:3], v[2:3] op_sel:[0,0,1] op_sel_hi:[1,0,1]
    v_cvt_pk_bf16_f32 v87, v58, v59
    v_cvt_pk_bf16_f32 v86, v56, v57
    v_cvt_pk_bf16_f32 v85, v54, v55
    v_cvt_pk_bf16_f32 v84, v52, v53
    v_pk_fma_f32 v[116:117], v[116:117], v[2:3], v[2:3] op_sel:[0,0,1] op_sel_hi:[1,0,1]
    v_pk_fma_f32 v[118:119], v[118:119], v[2:3], v[2:3] op_sel:[0,0,1] op_sel_hi:[1,0,1]
    v_pk_fma_f32 v[120:121], v[120:121], v[2:3], v[2:3] op_sel:[0,0,1] op_sel_hi:[1,0,1]
    v_pk_fma_f32 v[122:123], v[122:123], v[2:3], v[2:3] op_sel:[0,0,1] op_sel_hi:[1,0,1]
    v_pk_fma_f32 v[124:125], v[124:125], v[2:3], v[2:3] op_sel:[0,0,1] op_sel_hi:[1,0,1]
    v_pk_fma_f32 v[126:127], v[126:127], v[2:3], v[2:3] op_sel:[0,0,1] op_sel_hi:[1,0,1]
    v_pk_fma_f32 v[128:129], v[128:129], v[2:3], v[2:3] op_sel:[0,0,1] op_sel_hi:[1,0,1]
    v_pk_fma_f32 v[130:131], v[130:131], v[2:3], v[2:3] op_sel:[0,0,1] op_sel_hi:[1,0,1]
    v_pk_fma_f32 v[132:133], v[132:133], v[2:3], v[2:3] op_sel:[0,0,1] op_sel_hi:[1,0,1]
    v_pk_fma_f32 v[134:135], v[134:135], v[2:3], v[2:3] op_sel:[0,0,1] op_sel_hi:[1,0,1]
    v_pk_fma_f32 v[136:137], v[136:137], v[2:3], v[2:3] op_sel:[0,0,1] op_sel_hi:[1,0,1]
    v_pk_fma_f32 v[138:139], v[138:139], v[2:3], v[2:3] op_sel:[0,0,1] op_sel_hi:[1,0,1]
    v_pk_fma_f32 v[140:141], v[140:141], v[2:3], v[2:3] op_sel:[0,0,1] op_sel_hi:[1,0,1]
    v_pk_fma_f32 v[142:143], v[142:143], v[2:3], v[2:3] op_sel:[0,0,1] op_sel_hi:[1,0,1]
    v_pk_fma_f32 v[144:145], v[144:145], v[2:3], v[2:3] op_sel:[0,0,1] op_sel_hi:[1,0,1]
    v_pk_fma_f32 v[146:147], v[146:147], v[2:3], v[2:3] op_sel:[0,0,1] op_sel_hi:[1,0,1]
    v_pk_fma_f32 v[148:149], v[148:149], v[2:3], v[2:3] op_sel:[0,0,1] op_sel_hi:[1,0,1]
    v_pk_fma_f32 v[150:151], v[150:151], v[2:3], v[2:3] op_sel:[0,0,1] op_sel_hi:[1,0,1]
    v_pk_fma_f32 v[152:153], v[152:153], v[2:3], v[2:3] op_sel:[0,0,1] op_sel_hi:[1,0,1]
    v_pk_fma_f32 v[154:155], v[154:155], v[2:3], v[2:3] op_sel:[0,0,1] op_sel_hi:[1,0,1]
    v_pk_fma_f32 v[156:157], v[156:157], v[2:3], v[2:3] op_sel:[0,0,1] op_sel_hi:[1,0,1]
    v_pk_fma_f32 v[158:159], v[158:159], v[2:3], v[2:3] op_sel:[0,0,1] op_sel_hi:[1,0,1]
    v_pk_fma_f32 v[160:161], v[160:161], v[2:3], v[2:3] op_sel:[0,0,1] op_sel_hi:[1,0,1]
    v_pk_fma_f32 v[162:163], v[162:163], v[2:3], v[2:3] op_sel:[0,0,1] op_sel_hi:[1,0,1]
    v_pk_fma_f32 v[164:165], v[164:165], v[2:3], v[2:3] op_sel:[0,0,1] op_sel_hi:[1,0,1]
    v_pk_fma_f32 v[166:167], v[166:167], v[2:3], v[2:3] op_sel:[0,0,1] op_sel_hi:[1,0,1]
    v_pk_fma_f32 v[168:169], v[168:169], v[2:3], v[2:3] op_sel:[0,0,1] op_sel_hi:[1,0,1]
    v_pk_fma_f32 v[170:171], v[170:171], v[2:3], v[2:3] op_sel:[0,0,1] op_sel_hi:[1,0,1]
    v_pk_fma_f32 v[172:173], v[172:173], v[2:3], v[2:3] op_sel:[0,0,1] op_sel_hi:[1,0,1]
    v_pk_fma_f32 v[174:175], v[174:175], v[2:3], v[2:3] op_sel:[0,0,1] op_sel_hi:[1,0,1]
    v_pk_fma_f32 v[176:177], v[176:177], v[2:3], v[2:3] op_sel:[0,0,1] op_sel_hi:[1,0,1]
    v_pk_fma_f32 v[178:179], v[178:179], v[2:3], v[2:3] op_sel:[0,0,1] op_sel_hi:[1,0,1]
    v_pk_fma_f32 v[180:181], v[180:181], v[2:3], v[2:3] op_sel:[0,0,1] op_sel_hi:[1,0,1]
    v_pk_fma_f32 v[182:183], v[182:183], v[2:3], v[2:3] op_sel:[0,0,1] op_sel_hi:[1,0,1]
    v_pk_fma_f32 v[184:185], v[184:185], v[2:3], v[2:3] op_sel:[0,0,1] op_sel_hi:[1,0,1]
    v_pk_fma_f32 v[186:187], v[186:187], v[2:3], v[2:3] op_sel:[0,0,1] op_sel_hi:[1,0,1]
    s_barrier
    ds_read_b64_tr_b16 v[28:29], v20 offset:28672
    ds_read_b64_tr_b16 v[30:31], v20 offset:29184
    ds_read_b64_tr_b16 v[32:33], v24 offset:28672
    ds_read_b64_tr_b16 v[34:35], v24 offset:29184
    ds_read_b64_tr_b16 v[36:37], v21 offset:28672
    ds_read_b64_tr_b16 v[38:39], v21 offset:29184
    ds_read_b64_tr_b16 v[40:41], v25 offset:28672
    ds_read_b64_tr_b16 v[42:43], v25 offset:29184
    v_pk_fma_f32 v[188:189], v[188:189], v[2:3], v[2:3] op_sel:[0,0,1] op_sel_hi:[1,0,1]
    v_pk_fma_f32 v[190:191], v[190:191], v[2:3], v[2:3] op_sel:[0,0,1] op_sel_hi:[1,0,1]
    v_pk_fma_f32 v[192:193], v[192:193], v[2:3], v[2:3] op_sel:[0,0,1] op_sel_hi:[1,0,1]
    v_pk_fma_f32 v[194:195], v[194:195], v[2:3], v[2:3] op_sel:[0,0,1] op_sel_hi:[1,0,1]
    v_pk_fma_f32 v[196:197], v[196:197], v[2:3], v[2:3] op_sel:[0,0,1] op_sel_hi:[1,0,1]
    v_pk_fma_f32 v[198:199], v[198:199], v[2:3], v[2:3] op_sel:[0,0,1] op_sel_hi:[1,0,1]
    v_pk_fma_f32 v[200:201], v[200:201], v[2:3], v[2:3] op_sel:[0,0,1] op_sel_hi:[1,0,1]
    v_pk_fma_f32 v[202:203], v[202:203], v[2:3], v[2:3] op_sel:[0,0,1] op_sel_hi:[1,0,1]
    v_pk_fma_f32 v[204:205], v[204:205], v[2:3], v[2:3] op_sel:[0,0,1] op_sel_hi:[1,0,1]
    v_pk_fma_f32 v[206:207], v[206:207], v[2:3], v[2:3] op_sel:[0,0,1] op_sel_hi:[1,0,1]
    v_pk_fma_f32 v[208:209], v[208:209], v[2:3], v[2:3] op_sel:[0,0,1] op_sel_hi:[1,0,1]
    v_pk_fma_f32 v[210:211], v[210:211], v[2:3], v[2:3] op_sel:[0,0,1] op_sel_hi:[1,0,1]
    v_pk_fma_f32 v[212:213], v[212:213], v[2:3], v[2:3] op_sel:[0,0,1] op_sel_hi:[1,0,1]
    v_pk_fma_f32 v[214:215], v[214:215], v[2:3], v[2:3] op_sel:[0,0,1] op_sel_hi:[1,0,1]
    v_pk_fma_f32 v[216:217], v[216:217], v[2:3], v[2:3] op_sel:[0,0,1] op_sel_hi:[1,0,1]
    v_pk_fma_f32 v[218:219], v[218:219], v[2:3], v[2:3] op_sel:[0,0,1] op_sel_hi:[1,0,1]
    v_pk_fma_f32 v[220:221], v[220:221], v[2:3], v[2:3] op_sel:[0,0,1] op_sel_hi:[1,0,1]
    v_pk_fma_f32 v[222:223], v[222:223], v[2:3], v[2:3] op_sel:[0,0,1] op_sel_hi:[1,0,1]
    v_pk_fma_f32 v[224:225], v[224:225], v[2:3], v[2:3] op_sel:[0,0,1] op_sel_hi:[1,0,1]
    v_pk_fma_f32 v[226:227], v[226:227], v[2:3], v[2:3] op_sel:[0,0,1] op_sel_hi:[1,0,1]
    v_pk_fma_f32 v[228:229], v[228:229], v[2:3], v[2:3] op_sel:[0,0,1] op_sel_hi:[1,0,1]
    v_pk_fma_f32 v[230:231], v[230:231], v[2:3], v[2:3] op_sel:[0,0,1] op_sel_hi:[1,0,1]
    v_pk_fma_f32 v[232:233], v[232:233], v[2:3], v[2:3] op_sel:[0,0,1] op_sel_hi:[1,0,1]
    v_pk_fma_f32 v[234:235], v[234:235], v[2:3], v[2:3] op_sel:[0,0,1] op_sel_hi:[1,0,1]
    s_cmp_lg_u32 s67, 0
    s_cbranch_scc1 L_Ak
    s_waitcnt lgkmcnt(6)
    v_mfma_f32_32x32x16_bf16 v[52:67], v[28:31], v[84:87], 0
    ds_read_b64_tr_b16 v[44:45], v22 offset:28672
    ds_read_b64_tr_b16 v[46:47], v22 offset:29184
    v_lshlrev_b32 v7, 16, v236
    v_and_b32 v19, s10, v236
    v_fma_f32 v7, v7, v2, v3
    v_fma_f32 v19, v19, v2, v3
    s_waitcnt lgkmcnt(6)
    v_mfma_f32_32x32x16_bf16 v[68:83], v[32:35], v[84:87], 0
    ds_read_b64_tr_b16 v[48:49], v26 offset:28672
    ds_read_b64_tr_b16 v[50:51], v26 offset:29184
    v_cvt_pk_bf16_f32 v236, v7, v19
    v_lshlrev_b32 v1, 16, v237
    v_and_b32 v4, s10, v237
    s_waitcnt lgkmcnt(4)
    v_mfma_f32_32x32x16_bf16 v[52:67], v[36:39], v[88:91], v[52:67]
    ds_read_b64_tr_b16 v[28:29], v23 offset:28672
    ds_read_b64_tr_b16 v[30:31], v23 offset:29184
    v_fma_f32 v1, v1, v2, v3
    v_fma_f32 v4, v4, v2, v3
    v_cvt_pk_bf16_f32 v237, v1, v4
    v_lshlrev_b32 v7, 16, v238
    v_mfma_f32_32x32x16_bf16 v[68:83], v[40:43], v[88:91], v[68:83]
    ds_read_b64_tr_b16 v[32:33], v27 offset:28672
    ds_read_b64_tr_b16 v[34:35], v27 offset:29184
    v_and_b32 v19, s10, v238
    v_fma_f32 v7, v7, v2, v3
    v_fma_f32 v19, v19, v2, v3
    s_waitcnt lgkmcnt(4)
    v_mfma_f32_32x32x16_bf16 v[52:67], v[44:47], v[92:95], v[52:67]
    s_barrier
    ds_read_b64_tr_b16 v[36:37], v20 offset:30720
    ds_read_b64_tr_b16 v[38:39], v20 offset:31232
    v_cvt_pk_bf16_f32 v238, v7, v19
    v_lshlrev_b32 v1, 16, v239
    v_and_b32 v4, s10, v239
    v_fma_f32 v1, v1, v2, v3
    v_mfma_f32_32x32x16_bf16 v[68:83], v[48:51], v[92:95], v[68:83]
    ds_read_b64_tr_b16 v[40:41], v24 offset:30720
    ds_read_b64_tr_b16 v[42:43], v24 offset:31232
    v_fma_f32 v4, v4, v2, v3
    v_cvt_pk_bf16_f32 v239, v1, v4
    v_lshlrev_b32 v7, 16, v240
    s_waitcnt lgkmcnt(4)
    v_mfma_f32_32x32x16_bf16 v[52:67], v[28:31], v[96:99], v[52:67]
    ds_read_b64_tr_b16 v[44:45], v21 offset:30720
    ds_read_b64_tr_b16 v[46:47], v21 offset:31232
    v_and_b32 v19, s10, v240
    v_fma_f32 v7, v7, v2, v3
    v_fma_f32 v19, v19, v2, v3
    v_cvt_pk_bf16_f32 v240, v7, v19
    v_mfma_f32_32x32x16_bf16 v[68:83], v[32:35], v[96:99], v[68:83]
    ds_read_b64_tr_b16 v[48:49], v25 offset:30720
    ds_read_b64_tr_b16 v[50:51], v25 offset:31232
    v_lshlrev_b32 v1, 16, v241
    v_and_b32 v4, s10, v241
    v_fma_f32 v1, v1, v2, v3
    s_waitcnt lgkmcnt(4)
    v_mfma_f32_32x32x16_bf16 v[52:67], v[36:39], v[100:103], v[52:67]
    ds_read_b64_tr_b16 v[28:29], v22 offset:30720
    ds_read_b64_tr_b16 v[30:31], v22 offset:31232
    v_fma_f32 v4, v4, v2, v3
    v_cvt_pk_bf16_f32 v241, v1, v4
    v_lshlrev_b32 v7, 16, v242
    v_and_b32 v19, s10, v242
    v_mfma_f32_32x32x16_bf16 v[68:83], v[40:43], v[100:103], v[68:83]
    ds_read_b64_tr_b16 v[32:33], v26 offset:30720
    ds_read_b64_tr_b16 v[34:35], v26 offset:31232
    v_fma_f32 v7, v7, v2, v3
    v_fma_f32 v19, v19, v2, v3
    v_cvt_pk_bf16_f32 v242, v7, v19
    s_waitcnt lgkmcnt(4)
    v_mfma_f32_32x32x16_bf16 v[52:67], v[44:47], v[104:107], v[52:67]
    ds_read_b64_tr_b16 v[36:37], v23 offset:30720
    ds_read_b64_tr_b16 v[38:39], v23 offset:31232
    v_lshlrev_b32 v1, 16, v243
    v_and_b32 v4, s10, v243
    v_fma_f32 v1, v1, v2, v3
    v_fma_f32 v4, v4, v2, v3
    v_mfma_f32_32x32x16_bf16 v[68:83], v[48:51], v[104:107], v[68:83]
    ds_read_b64_tr_b16 v[40:41], v27 offset:30720
    ds_read_b64_tr_b16 v[42:43], v27 offset:31232
    v_cvt_pk_bf16_f32 v243, v1, v4
    v_lshlrev_b32 v7, 16, v244
    v_and_b32 v19, s10, v244
    s_waitcnt lgkmcnt(4)
    v_mfma_f32_32x32x16_bf16 v[52:67], v[28:31], v[108:111], v[52:67]
    s_barrier
    ds_read_b64_tr_b16 v[44:45], v20 offset:32768
    ds_read_b64_tr_b16 v[46:47], v20 offset:33280
    v_fma_f32 v7, v7, v2, v3
    v_fma_f32 v19, v19, v2, v3
    v_cvt_pk_bf16_f32 v116, v116, v117
    v_cvt_pk_bf16_f32 v117, v118, v119
    v_mfma_f32_32x32x16_bf16 v[68:83], v[32:35], v[108:111], v[68:83]
    ds_read_b64_tr_b16 v[48:49], v24 offset:32768
    ds_read_b64_tr_b16 v[50:51], v24 offset:33280
    v_cvt_pk_bf16_f32 v244, v7, v19
    v_cvt_pk_bf16_f32 v118, v120, v121
    v_cvt_pk_bf16_f32 v119, v122, v123
    s_waitcnt lgkmcnt(4)
    v_mfma_f32_32x32x16_bf16 v[52:67], v[36:39], v[112:115], v[52:67]
    ds_read_b64_tr_b16 v[28:29], v21 offset:32768
    ds_read_b64_tr_b16 v[30:31], v21 offset:33280
    v_lshlrev_b32 v1, 16, v245
    v_and_b32 v4, s10, v245
    v_cvt_pk_bf16_f32 v120, v124, v125
    v_cvt_pk_bf16_f32 v121, v126, v127
    v_mfma_f32_32x32x16_bf16 v[68:83], v[40:43], v[112:115], v[68:83]
    ds_read_b64_tr_b16 v[32:33], v25 offset:32768
    ds_read_b64_tr_b16 v[34:35], v25 offset:33280
    v_fma_f32 v1, v1, v2, v3
    v_cvt_pk_bf16_f32 v122, v128, v129
    v_cvt_pk_bf16_f32 v123, v130, v131
    s_waitcnt lgkmcnt(4)
    v_mfma_f32_32x32x16_bf16 v[52:67], v[44:47], v[116:119], v[52:67]
    ds_read_b64_tr_b16 v[36:37], v22 offset:32768
    ds_read_b64_tr_b16 v[38:39], v22 offset:33280
    v_fma_f32 v4, v4, v2, v3
    v_cvt_pk_bf16_f32 v245, v1, v4
    v_cvt_pk_bf16_f32 v124, v132, v133
    v_cvt_pk_bf16_f32 v125, v134, v135
    v_mfma_f32_32x32x16_bf16 v[68:83], v[48:51], v[116:119], v[68:83]
    ds_read_b64_tr_b16 v[40:41], v26 offset:32768
    ds_read_b64_tr_b16 v[42:43], v26 offset:33280
    v_lshlrev_b32 v7, 16, v246
    v_cvt_pk_bf16_f32 v126, v136, v137
    v_cvt_pk_bf16_f32 v127, v138, v139
    s_waitcnt lgkmcnt(4)
    v_mfma_f32_32x32x16_bf16 v[52:67], v[28:31], v[120:123], v[52:67]
    ds_read_b64_tr_b16 v[44:45], v23 offset:32768
    ds_read_b64_tr_b16 v[46:47], v23 offset:33280
    v_and_b32 v19, s10, v246
    v_fma_f32 v7, v7, v2, v3
    v_cvt_pk_bf16_f32 v128, v140, v141
    v_cvt_pk_bf16_f32 v129, v142, v143
    v_mfma_f32_32x32x16_bf16 v[68:83], v[32:35], v[120:123], v[68:83]
    ds_read_b64_tr_b16 v[48:49], v27 offset:32768
    ds_read_b64_tr_b16 v[50:51], v27 offset:33280
    v_fma_f32 v19, v19, v2, v3
    v_cvt_pk_bf16_f32 v130, v144, v145
    v_cvt_pk_bf16_f32 v131, v146, v147
    s_waitcnt lgkmcnt(4)
    v_mfma_f32_32x32x16_bf16 v[52:67], v[36:39], v[124:127], v[52:67]
    ds_read_b64_tr_b16 v[28:29], v20 offset:34816
    ds_read_b64_tr_b16 v[30:31], v20 offset:35328
    v_cvt_pk_bf16_f32 v246, v7, v19
    v_lshlrev_b32 v1, 16, v247
    v_cvt_pk_bf16_f32 v132, v148, v149
    v_cvt_pk_bf16_f32 v133, v150, v151
    v_mfma_f32_32x32x16_bf16 v[68:83], v[40:43], v[124:127], v[68:83]
    ds_read_b64_tr_b16 v[32:33], v24 offset:34816
    ds_read_b64_tr_b16 v[34:35], v24 offset:35328
    v_and_b32 v4, s10, v247
    v_cvt_pk_bf16_f32 v134, v152, v153
    v_cvt_pk_bf16_f32 v135, v154, v155
    s_waitcnt lgkmcnt(4)
    v_mfma_f32_32x32x16_bf16 v[52:67], v[44:47], v[128:131], v[52:67]
    ds_read_b64_tr_b16 v[36:37], v21 offset:34816
    ds_read_b64_tr_b16 v[38:39], v21 offset:35328
    v_fma_f32 v1, v1, v2, v3
    v_fma_f32 v4, v4, v2, v3
    v_cvt_pk_bf16_f32 v136, v156, v157
    v_cvt_pk_bf16_f32 v137, v158, v159
    v_mfma_f32_32x32x16_bf16 v[68:83], v[48:51], v[128:131], v[68:83]
    ds_read_b64_tr_b16 v[40:41], v25 offset:34816
    ds_read_b64_tr_b16 v[42:43], v25 offset:35328
    v_cvt_pk_bf16_f32 v247, v1, v4
    v_cvt_pk_bf16_f32 v138, v160, v161
    v_cvt_pk_bf16_f32 v139, v162, v163
    s_waitcnt lgkmcnt(4)
    v_mfma_f32_32x32x16_bf16 v[52:67], v[28:31], v[132:135], v[52:67]
    ds_read_b64_tr_b16 v[44:45], v22 offset:34816
    ds_read_b64_tr_b16 v[46:47], v22 offset:35328
    v_lshlrev_b32 v7, 16, v248
    v_and_b32 v19, s10, v248
    v_cvt_pk_bf16_f32 v140, v164, v165
    v_cvt_pk_bf16_f32 v141, v166, v167
    v_mfma_f32_32x32x16_bf16 v[68:83], v[32:35], v[132:135], v[68:83]
    ds_read_b64_tr_b16 v[48:49], v26 offset:34816
    ds_read_b64_tr_b16 v[50:51], v26 offset:35328
    v_fma_f32 v7, v7, v2, v3
    v_cvt_pk_bf16_f32 v142, v168, v169
    v_cvt_pk_bf16_f32 v143, v170, v171
    s_waitcnt lgkmcnt(4)
    v_mfma_f32_32x32x16_bf16 v[52:67], v[36:39], v[136:139], v[52:67]
    ds_read_b64_tr_b16 v[28:29], v23 offset:34816
    ds_read_b64_tr_b16 v[30:31], v23 offset:35328
    v_fma_f32 v19, v19, v2, v3
    v_cvt_pk_bf16_f32 v248, v7, v19
    v_cvt_pk_bf16_f32 v144, v172, v173
    v_cvt_pk_bf16_f32 v145, v174, v175
    v_mfma_f32_32x32x16_bf16 v[68:83], v[40:43], v[136:139], v[68:83]
    ds_read_b64_tr_b16 v[32:33], v27 offset:34816
    ds_read_b64_tr_b16 v[34:35], v27 offset:35328
    v_lshlrev_b32 v1, 16, v249
    v_cvt_pk_bf16_f32 v146, v176, v177
    v_cvt_pk_bf16_f32 v147, v178, v179
    s_waitcnt lgkmcnt(4)
    v_mfma_f32_32x32x16_bf16 v[52:67], v[44:47], v[140:143], v[52:67]
    s_barrier
    ds_read_b64_tr_b16 v[36:37], v20 offset:36864
    ds_read_b64_tr_b16 v[38:39], v20 offset:37376
    v_and_b32 v4, s10, v249
    v_fma_f32 v1, v1, v2, v3
    v_cvt_pk_bf16_f32 v148, v180, v181
    v_cvt_pk_bf16_f32 v149, v182, v183
    v_mfma_f32_32x32x16_bf16 v[68:83], v[48:51], v[140:143], v[68:83]
    ds_read_b64_tr_b16 v[40:41], v24 offset:36864
    ds_read_b64_tr_b16 v[42:43], v24 offset:37376
    v_fma_f32 v4, v4, v2, v3
    v_cvt_pk_bf16_f32 v150, v184, v185
    v_cvt_pk_bf16_f32 v151, v186, v187
    s_waitcnt lgkmcnt(4)
    v_mfma_f32_32x32x16_bf16 v[52:67], v[28:31], v[144:147], v[52:67]
    ds_read_b64_tr_b16 v[44:45], v21 offset:36864
    ds_read_b64_tr_b16 v[46:47], v21 offset:37376
    v_cvt_pk_bf16_f32 v249, v1, v4
    v_lshlrev_b32 v7, 16, v250
    v_cvt_pk_bf16_f32 v152, v188, v189
    v_cvt_pk_bf16_f32 v153, v190, v191
    v_mfma_f32_32x32x16_bf16 v[68:83], v[32:35], v[144:147], v[68:83]
    ds_read_b64_tr_b16 v[48:49], v25 offset:36864
    ds_read_b64_tr_b16 v[50:51], v25 offset:37376
    v_and_b32 v19, s10, v250
    v_cvt_pk_bf16_f32 v154, v192, v193
    v_cvt_pk_bf16_f32 v155, v194, v195
    s_waitcnt lgkmcnt(4)
    v_mfma_f32_32x32x16_bf16 v[52:67], v[36:39], v[148:151], v[52:67]
    ds_read_b64_tr_b16 v[28:29], v22 offset:36864
    ds_read_b64_tr_b16 v[30:31], v22 offset:37376
    v_fma_f32 v7, v7, v2, v3
    v_fma_f32 v19, v19, v2, v3
    v_cvt_pk_bf16_f32 v156, v196, v197
    v_cvt_pk_bf16_f32 v157, v198, v199
    v_mfma_f32_32x32x16_bf16 v[68:83], v[40:43], v[148:151], v[68:83]
    ds_read_b64_tr_b16 v[32:33], v26 offset:36864
    ds_read_b64_tr_b16 v[34:35], v26 offset:37376
    v_cvt_pk_bf16_f32 v250, v7, v19
    v_cvt_pk_bf16_f32 v158, v200, v201
    v_cvt_pk_bf16_f32 v159, v202, v203
    v_lshlrev_b32 v1, 16, v251
    s_waitcnt lgkmcnt(4)
    v_mfma_f32_32x32x16_bf16 v[52:67], v[44:47], v[152:155], v[52:67]
    ds_read_b64_tr_b16 v[36:37], v23 offset:36864
    ds_read_b64_tr_b16 v[38:39], v23 offset:37376
    v_and_b32 v4, s10, v251
    v_fma_f32 v1, v1, v2, v3
    v_cvt_pk_bf16_f32 v160, v204, v205
    v_cvt_pk_bf16_f32 v161, v206, v207
    v_fma_f32 v4, v4, v2, v3
    v_mfma_f32_32x32x16_bf16 v[68:83], v[48:51], v[152:155], v[68:83]
    ds_read_b64_tr_b16 v[40:41], v27 offset:36864
    ds_read_b64_tr_b16 v[42:43], v27 offset:37376
    v_cvt_pk_bf16_f32 v251, v1, v4
    v_cvt_pk_bf16_f32 v162, v208, v209
    v_cvt_pk_bf16_f32 v163, v210, v211
    v_lshlrev_b32 v7, 16, v252
    s_waitcnt lgkmcnt(4)
    v_mfma_f32_32x32x16_bf16 v[52:67], v[28:31], v[156:159], v[52:67]
    ds_read_b64_tr_b16 v[44:45], v20 offset:38912
    ds_read_b64_tr_b16 v[46:47], v20 offset:39424
    v_and_b32 v19, s10, v252
    v_fma_f32 v7, v7, v2, v3
    v_cvt_pk_bf16_f32 v164, v212, v213
    v_cvt_pk_bf16_f32 v165, v214, v215
    v_fma_f32 v19, v19, v2, v3
    v_mfma_f32_32x32x16_bf16 v[68:83], v[32:35], v[156:159], v[68:83]
    ds_read_b64_tr_b16 v[48:49], v24 offset:38912
    ds_read_b64_tr_b16 v[50:51], v24 offset:39424
    v_cvt_pk_bf16_f32 v252, v7, v19
    v_cvt_pk_bf16_f32 v166, v216, v217
    v_cvt_pk_bf16_f32 v167, v218, v219
    v_lshlrev_b32 v1, 16, v253
    s_waitcnt lgkmcnt(4)
    v_mfma_f32_32x32x16_bf16 v[52:67], v[36:39], v[160:163], v[52:67]
    ds_read_b64_tr_b16 v[28:29], v21 offset:38912
    ds_read_b64_tr_b16 v[30:31], v21 offset:39424
    v_and_b32 v4, s10, v253
    v_fma_f32 v1, v1, v2, v3
    v_cvt_pk_bf16_f32 v168, v220, v221
    v_cvt_pk_bf16_f32 v169, v222, v223
    v_mfma_f32_32x32x16_bf16 v[68:83], v[40:43], v[160:163], v[68:83]
    ds_read_b64_tr_b16 v[32:33], v25 offset:38912
    ds_read_b64_tr_b16 v[34:35], v25 offset:39424
    v_cvt_pk_bf16_f32 v170, v224, v225
    v_cvt_pk_bf16_f32 v171, v226, v227
    v_and_b32 v12, 31, v0
    v_lshlrev_b32 v12, 1, v12
    v_fma_f32 v4, v4, v2, v3
    v_cvt_pk_bf16_f32 v253, v1, v4
    v_lshlrev_b32 v7, 16, v254
    s_waitcnt lgkmcnt(4)
    v_mfma_f32_32x32x16_bf16 v[52:67], v[44:47], v[164:167], v[52:67]
    ds_read_b64_tr_b16 v[36:37], v22 offset:38912
    ds_read_b64_tr_b16 v[38:39], v22 offset:39424
    v_and_b32 v19, s10, v254
    v_cvt_pk_bf16_f32 v172, v228, v229
    v_cvt_pk_bf16_f32 v173, v230, v231
    buffer_load_ushort v208, v12, s[32:35], s55 offen offset:0
    v_fma_f32 v7, v7, v2, v3
    v_mfma_f32_32x32x16_bf16 v[68:83], v[48:51], v[164:167], v[68:83]
    ds_read_b64_tr_b16 v[40:41], v26 offset:38912
    ds_read_b64_tr_b16 v[42:43], v26 offset:39424
    v_cvt_pk_bf16_f32 v174, v232, v233
    v_cvt_pk_bf16_f32 v175, v234, v235
    buffer_load_ushort v210, v12, s[32:35], s55 offen offset:64
    v_fma_f32 v19, v19, v2, v3
    v_cvt_pk_bf16_f32 v254, v7, v19
    v_lshlrev_b32 v1, 16, v255
    s_waitcnt lgkmcnt(4)
    v_mfma_f32_32x32x16_bf16 v[52:67], v[28:31], v[168:171], v[52:67]
    ds_read_b64_tr_b16 v[44:45], v23 offset:38912
    ds_read_b64_tr_b16 v[46:47], v23 offset:39424
    v_and_b32 v4, s10, v255
    v_fma_f32 v1, v1, v2, v3
    v_fma_f32 v4, v4, v2, v3
    buffer_load_ushort v212, v12, s[32:35], s55 offen offset:1024
    v_mfma_f32_32x32x16_bf16 v[68:83], v[32:35], v[168:171], v[68:83]
    ds_read_b64_tr_b16 v[48:49], v27 offset:38912
    ds_read_b64_tr_b16 v[50:51], v27 offset:39424
    v_cvt_pk_bf16_f32 v255, v1, v4
    buffer_load_ushort v214, v12, s[32:35], s55 offen offset:1088
    s_waitcnt lgkmcnt(4)
    v_mfma_f32_32x32x16_bf16 v[52:67], v[36:39], v[172:175], v[52:67]
    ds_read_b64_tr_b16 v[28:29], v20 offset:0
    ds_read_b64_tr_b16 v[30:31], v20 offset:512
    buffer_load_ushort v216, v12, s[32:35], s55 offen offset:2048
    v_mfma_f32_32x32x16_bf16 v[68:83], v[40:43], v[172:175], v[68:83]
    ds_read_b64_tr_b16 v[32:33], v24 offset:0
    ds_read_b64_tr_b16 v[34:35], v24 offset:512
    buffer_load_ushort v218, v12, s[32:35], s55 offen offset:2112
    s_waitcnt lgkmcnt(4)
    v_mfma_f32_32x32x16_bf16 v[52:67], v[44:47], v[236:239], v[52:67]
    ds_read_b64_tr_b16 v[36:37], v21 offset:0
    ds_read_b64_tr_b16 v[38:39], v21 offset:512
    buffer_load_ushort v220, v12, s[32:35], s56 offen offset:3072
    v_mfma_f32_32x32x16_bf16 v[68:83], v[48:51], v[236:239], v[68:83]
    ds_read_b64_tr_b16 v[40:41], v25 offset:0
    ds_read_b64_tr_b16 v[42:43], v25 offset:512
    s_waitcnt lgkmcnt(4)
    v_mfma_f32_32x32x16_bf16 v[52:67], v[28:31], v[240:243], v[52:67]
    ds_read_b64_tr_b16 v[44:45], v22 offset:0
    ds_read_b64_tr_b16 v[46:47], v22 offset:512
    v_mov_b32 v209, 0
    v_mov_b32 v211, 0
    v_mov_b32 v213, 0
    v_mov_b32 v215, 0
    v_mfma_f32_32x32x16_bf16 v[68:83], v[32:35], v[240:243], v[68:83]
    ds_read_b64_tr_b16 v[48:49], v26 offset:0
    ds_read_b64_tr_b16 v[50:51], v26 offset:512
    v_mov_b32 v217, 0
    v_mov_b32 v219, 0
    v_mov_b32 v221, 0
    s_waitcnt lgkmcnt(4)
    v_mfma_f32_32x32x16_bf16 v[52:67], v[36:39], v[244:247], v[52:67]
    ds_read_b64_tr_b16 v[28:29], v23 offset:0
    ds_read_b64_tr_b16 v[30:31], v23 offset:512
    v_mov_b32 v223, 0
    v_mov_b32 v224, 0
    v_mov_b32 v225, 0
    v_mfma_f32_32x32x16_bf16 v[68:83], v[40:43], v[244:247], v[68:83]
    ds_read_b64_tr_b16 v[32:33], v27 offset:0
    ds_read_b64_tr_b16 v[34:35], v27 offset:512
    v_mov_b32 v222, 0x3f80
    v_cndmask_b32 v222, v222, 0, s[82:83]
    s_waitcnt lgkmcnt(4)
    v_mfma_f32_32x32x16_bf16 v[52:67], v[44:47], v[248:251], v[52:67]
    s_barrier
    ds_read_b64_tr_b16 v[36:37], v20 offset:2048
    ds_read_b64_tr_b16 v[38:39], v20 offset:2560
    v_mfma_f32_32x32x16_bf16 v[68:83], v[48:51], v[248:251], v[68:83]
    ds_read_b64_tr_b16 v[40:41], v24 offset:2048
    ds_read_b64_tr_b16 v[42:43], v24 offset:2560
    s_waitcnt lgkmcnt(4)
    v_mfma_f32_32x32x16_bf16 v[52:67], v[28:31], v[252:255], v[52:67]
    ds_read_b64_tr_b16 v[44:45], v21 offset:2048
    ds_read_b64_tr_b16 v[46:47], v21 offset:2560
    v_mfma_f32_32x32x16_bf16 v[68:83], v[32:35], v[252:255], v[68:83]
    ds_read_b64_tr_b16 v[48:49], v25 offset:2048
    ds_read_b64_tr_b16 v[50:51], v25 offset:2560
    s_waitcnt lgkmcnt(4)
    v_mfma_f32_32x32x16_bf16 v[176:191], v[36:39], v[84:87], 0
    ds_read_b64_tr_b16 v[28:29], v22 offset:2048
    ds_read_b64_tr_b16 v[30:31], v22 offset:2560
    v_and_b32 v19, 15, v0
    v_lshlrev_b32 v19, 2, v19
    global_load_dword v19, v19, s[22:23] sc1
    v_mfma_f32_32x32x16_bf16 v[192:207], v[40:43], v[84:87], 0
    ds_read_b64_tr_b16 v[32:33], v26 offset:2048
    ds_read_b64_tr_b16 v[34:35], v26 offset:2560
    s_waitcnt lgkmcnt(4)
    v_mfma_f32_32x32x16_bf16 v[176:191], v[44:47], v[88:91], v[176:191]
    ds_read_b64_tr_b16 v[36:37], v23 offset:2048
    ds_read_b64_tr_b16 v[38:39], v23 offset:2560
    v_mfma_f32_32x32x16_bf16 v[192:207], v[48:51], v[88:91], v[192:207]
    ds_read_b64_tr_b16 v[40:41], v27 offset:2048
    ds_read_b64_tr_b16 v[42:43], v27 offset:2560
    s_waitcnt lgkmcnt(4)
    v_mfma_f32_32x32x16_bf16 v[176:191], v[28:31], v[92:95], v[176:191]
    ds_read_b64_tr_b16 v[44:45], v20 offset:4096
    ds_read_b64_tr_b16 v[46:47], v20 offset:4608
    v_mfma_f32_32x32x16_bf16 v[192:207], v[32:35], v[92:95], v[192:207]
    ds_read_b64_tr_b16 v[48:49], v24 offset:4096
    ds_read_b64_tr_b16 v[50:51], v24 offset:4608
    s_waitcnt vmcnt(1)
    v_mfma_f32_32x32x16_bf16 v[52:67], v[208:211], v[222:225], v[52:67]
    v_mfma_f32_32x32x16_bf16 v[68:83], v[210:213], v[222:225], v[68:83]
    s_waitcnt lgkmcnt(4)
    v_mfma_f32_32x32x16_bf16 v[176:191], v[36:39], v[96:99], v[176:191]
    ds_read_b64_tr_b16 v[28:29], v21 offset:4096
    ds_read_b64_tr_b16 v[30:31], v21 offset:4608
    v_mfma_f32_32x32x16_bf16 v[176:191], v[212:215], v[222:225], v[176:191]
    v_mfma_f32_32x32x16_bf16 v[192:207], v[214:217], v[222:225], v[192:207]
    v_mfma_f32_32x32x16_bf16 v[192:207], v[40:43], v[96:99], v[192:207]
    ds_read_b64_tr_b16 v[32:33], v25 offset:4096
    ds_read_b64_tr_b16 v[34:35], v25 offset:4608
    s_waitcnt lgkmcnt(4)
    v_mfma_f32_32x32x16_bf16 v[176:191], v[44:47], v[100:103], v[176:191]
    ds_read_b64_tr_b16 v[36:37], v22 offset:4096
    ds_read_b64_tr_b16 v[38:39], v22 offset:4608
    v_mul_f32_e64 v52, v52, |v52|
    v_mul_f32_e64 v53, v53, |v53|
    v_cvt_pk_bf16_f32 v52, v52, v53
    v_pk_max_i16 v52, v52, 0
    v_mul_f32_e64 v54, v54, |v54|
    v_mul_f32_e64 v55, v55, |v55|
    v_mfma_f32_32x32x16_bf16 v[192:207], v[48:51], v[100:103], v[192:207]
    ds_read_b64_tr_b16 v[40:41], v26 offset:4096
    ds_read_b64_tr_b16 v[42:43], v26 offset:4608
    v_cvt_pk_bf16_f32 v53, v54, v55
    v_pk_max_i16 v53, v53, 0
    v_mul_f32_e64 v56, v56, |v56|
    v_mul_f32_e64 v57, v57, |v57|
    v_cvt_pk_bf16_f32 v54, v56, v57
    s_waitcnt lgkmcnt(4)
    v_mfma_f32_32x32x16_bf16 v[176:191], v[28:31], v[104:107], v[176:191]
    ds_read_b64_tr_b16 v[44:45], v23 offset:4096
    ds_read_b64_tr_b16 v[46:47], v23 offset:4608
    v_pk_max_i16 v54, v54, 0
    v_mul_f32_e64 v58, v58, |v58|
    v_mul_f32_e64 v59, v59, |v59|
    v_cvt_pk_bf16_f32 v55, v58, v59
    v_pk_max_i16 v55, v55, 0
    buffer_store_dwordx4 v[52:55], v18, s[36:39], s53 offen offset:0 sc1
    v_mfma_f32_32x32x16_bf16 v[192:207], v[32:35], v[104:107], v[192:207]
    ds_read_b64_tr_b16 v[48:49], v27 offset:4096
    ds_read_b64_tr_b16 v[50:51], v27 offset:4608
    v_mul_f32_e64 v60, v60, |v60|
    v_mul_f32_e64 v61, v61, |v61|
    v_cvt_pk_bf16_f32 v56, v60, v61
    v_pk_max_i16 v56, v56, 0
    v_mul_f32_e64 v62, v62, |v62|
    s_waitcnt lgkmcnt(4)
    v_mfma_f32_32x32x16_bf16 v[176:191], v[36:39], v[108:111], v[176:191]
    ds_read_b64_tr_b16 v[28:29], v20 offset:6144
    ds_read_b64_tr_b16 v[30:31], v20 offset:6656
    v_mul_f32_e64 v63, v63, |v63|
    v_cvt_pk_bf16_f32 v57, v62, v63
    v_pk_max_i16 v57, v57, 0
    v_mul_f32_e64 v64, v64, |v64|
    v_mul_f32_e64 v65, v65, |v65|
    v_cvt_pk_bf16_f32 v58, v64, v65
    v_mfma_f32_32x32x16_bf16 v[192:207], v[40:43], v[108:111], v[192:207]
    ds_read_b64_tr_b16 v[32:33], v24 offset:6144
    ds_read_b64_tr_b16 v[34:35], v24 offset:6656
    v_pk_max_i16 v58, v58, 0
    v_mul_f32_e64 v66, v66, |v66|
    v_mul_f32_e64 v67, v67, |v67|
    v_cvt_pk_bf16_f32 v59, v66, v67
    v_pk_max_i16 v59, v59, 0
    s_waitcnt lgkmcnt(4)
    v_mfma_f32_32x32x16_bf16 v[176:191], v[44:47], v[112:115], v[176:191]
    ds_read_b64_tr_b16 v[36:37], v21 offset:6144
    ds_read_b64_tr_b16 v[38:39], v21 offset:6656
    buffer_store_dwordx4 v[56:59], v18, s[36:39], s53 offen offset:1024 sc1
    v_mul_f32_e64 v68, v68, |v68|
    v_mul_f32_e64 v69, v69, |v69|
    v_cvt_pk_bf16_f32 v68, v68, v69
    v_pk_max_i16 v68, v68, 0
    v_mul_f32_e64 v70, v70, |v70|
    v_mfma_f32_32x32x16_bf16 v[192:207], v[48:51], v[112:115], v[192:207]
    ds_read_b64_tr_b16 v[40:41], v25 offset:6144
    ds_read_b64_tr_b16 v[42:43], v25 offset:6656
    v_mul_f32_e64 v71, v71, |v71|
    v_cvt_pk_bf16_f32 v69, v70, v71
    v_pk_max_i16 v69, v69, 0
    v_mul_f32_e64 v72, v72, |v72|
    v_mul_f32_e64 v73, v73, |v73|
    s_waitcnt lgkmcnt(4)
    v_mfma_f32_32x32x16_bf16 v[176:191], v[28:31], v[116:119], v[176:191]
    ds_read_b64_tr_b16 v[44:45], v22 offset:6144
    ds_read_b64_tr_b16 v[46:47], v22 offset:6656
    v_cvt_pk_bf16_f32 v70, v72, v73
    v_pk_max_i16 v70, v70, 0
    v_mul_f32_e64 v74, v74, |v74|
    v_mul_f32_e64 v75, v75, |v75|
    v_cvt_pk_bf16_f32 v71, v74, v75
    v_pk_max_i16 v71, v71, 0
    v_mfma_f32_32x32x16_bf16 v[192:207], v[32:35], v[116:119], v[192:207]
    ds_read_b64_tr_b16 v[48:49], v26 offset:6144
    ds_read_b64_tr_b16 v[50:51], v26 offset:6656
    buffer_store_dwordx4 v[68:71], v18, s[36:39], s53 offen offset:2048 sc1
    v_mul_f32_e64 v76, v76, |v76|
    v_mul_f32_e64 v77, v77, |v77|
    v_cvt_pk_bf16_f32 v72, v76, v77
    v_pk_max_i16 v72, v72, 0
    s_waitcnt lgkmcnt(4)
    v_mfma_f32_32x32x16_bf16 v[176:191], v[36:39], v[120:123], v[176:191]
    ds_read_b64_tr_b16 v[28:29], v23 offset:6144
    ds_read_b64_tr_b16 v[30:31], v23 offset:6656
    v_mul_f32_e64 v78, v78, |v78|
    v_mul_f32_e64 v79, v79, |v79|
    v_cvt_pk_bf16_f32 v73, v78, v79
    v_pk_max_i16 v73, v73, 0
    v_mul_f32_e64 v80, v80, |v80|
    v_mul_f32_e64 v81, v81, |v81|
    v_mfma_f32_32x32x16_bf16 v[192:207], v[40:43], v[120:123], v[192:207]
    ds_read_b64_tr_b16 v[32:33], v27 offset:6144
    ds_read_b64_tr_b16 v[34:35], v27 offset:6656
    v_cvt_pk_bf16_f32 v74, v80, v81
    v_pk_max_i16 v74, v74, 0
    v_mul_f32_e64 v82, v82, |v82|
    v_mul_f32_e64 v83, v83, |v83|
    v_cvt_pk_bf16_f32 v75, v82, v83
    s_waitcnt lgkmcnt(4)
    v_mfma_f32_32x32x16_bf16 v[176:191], v[44:47], v[124:127], v[176:191]
    ds_read_b64_tr_b16 v[36:37], v20 offset:8192
    ds_read_b64_tr_b16 v[38:39], v20 offset:8704
    v_pk_max_i16 v75, v75, 0
    buffer_store_dwordx4 v[72:75], v18, s[36:39], s53 offen offset:3072 sc1
    s_waitcnt vmcnt(4)
    v_cmp_eq_u32 vcc, 0, v19
    s_cbranch_vccnz L_gol_2
L_go_1:
    v_mfma_f32_32x32x16_bf16 v[192:207], v[48:51], v[124:127], v[192:207]
    ds_read_b64_tr_b16 v[40:41], v24 offset:8192
    ds_read_b64_tr_b16 v[42:43], v24 offset:8704
    s_waitcnt lgkmcnt(4)
    v_mfma_f32_32x32x16_bf16 v[176:191], v[28:31], v[128:131], v[176:191]
    ds_read_b64_tr_b16 v[44:45], v21 offset:8192
    ds_read_b64_tr_b16 v[46:47], v21 offset:8704
    v_mfma_f32_32x32x16_bf16 v[192:207], v[32:35], v[128:131], v[192:207]
    ds_read_b64_tr_b16 v[48:49], v25 offset:8192
    ds_read_b64_tr_b16 v[50:51], v25 offset:8704
    s_waitcnt lgkmcnt(4)
    v_mfma_f32_32x32x16_bf16 v[176:191], v[36:39], v[132:135], v[176:191]
    ds_read_b64_tr_b16 v[28:29], v22 offset:8192
    ds_read_b64_tr_b16 v[30:31], v22 offset:8704
    v_mfma_f32_32x32x16_bf16 v[192:207], v[40:43], v[132:135], v[192:207]
    ds_read_b64_tr_b16 v[32:33], v26 offset:8192
    ds_read_b64_tr_b16 v[34:35], v26 offset:8704
    s_waitcnt lgkmcnt(4)
    v_mfma_f32_32x32x16_bf16 v[176:191], v[44:47], v[136:139], v[176:191]
    ds_read_b64_tr_b16 v[36:37], v23 offset:8192
    ds_read_b64_tr_b16 v[38:39], v23 offset:8704
    v_mfma_f32_32x32x16_bf16 v[192:207], v[48:51], v[136:139], v[192:207]
    ds_read_b64_tr_b16 v[40:41], v27 offset:8192
    ds_read_b64_tr_b16 v[42:43], v27 offset:8704
    s_waitcnt lgkmcnt(4)
    v_mfma_f32_32x32x16_bf16 v[176:191], v[28:31], v[140:143], v[176:191]
    s_barrier
    ds_read_b64_tr_b16 v[44:45], v20 offset:10240
    ds_read_b64_tr_b16 v[46:47], v20 offset:10752
    v_mfma_f32_32x32x16_bf16 v[192:207], v[32:35], v[140:143], v[192:207]
    ds_read_b64_tr_b16 v[48:49], v24 offset:10240
    ds_read_b64_tr_b16 v[50:51], v24 offset:10752
    s_waitcnt lgkmcnt(4)
    v_mfma_f32_32x32x16_bf16 v[176:191], v[36:39], v[144:147], v[176:191]
    ds_read_b64_tr_b16 v[28:29], v21 offset:10240
    ds_read_b64_tr_b16 v[30:31], v21 offset:10752
    v_mfma_f32_32x32x16_bf16 v[192:207], v[40:43], v[144:147], v[192:207]
    ds_read_b64_tr_b16 v[32:33], v25 offset:10240
    ds_read_b64_tr_b16 v[34:35], v25 offset:10752
    s_waitcnt lgkmcnt(4)
    v_mfma_f32_32x32x16_bf16 v[176:191], v[44:47], v[148:151], v[176:191]
    ds_read_b64_tr_b16 v[36:37], v22 offset:10240
    ds_read_b64_tr_b16 v[38:39], v22 offset:10752
    v_mfma_f32_32x32x16_bf16 v[192:207], v[48:51], v[148:151], v[192:207]
    ds_read_b64_tr_b16 v[40:41], v26 offset:10240
    ds_read_b64_tr_b16 v[42:43], v26 offset:10752
    s_waitcnt lgkmcnt(4)
    v_mfma_f32_32x32x16_bf16 v[176:191], v[28:31], v[152:155], v[176:191]
    ds_read_b64_tr_b16 v[44:45], v23 offset:10240
    ds_read_b64_tr_b16 v[46:47], v23 offset:10752
    v_mfma_f32_32x32x16_bf16 v[192:207], v[32:35], v[152:155], v[192:207]
    ds_read_b64_tr_b16 v[48:49], v27 offset:10240
    ds_read_b64_tr_b16 v[50:51], v27 offset:10752
    s_waitcnt lgkmcnt(4)
    v_mfma_f32_32x32x16_bf16 v[176:191], v[36:39], v[156:159], v[176:191]
    ds_read_b64_tr_b16 v[28:29], v20 offset:12288
    ds_read_b64_tr_b16 v[30:31], v20 offset:12800
    v_mfma_f32_32x32x16_bf16 v[192:207], v[40:43], v[156:159], v[192:207]
    ds_read_b64_tr_b16 v[32:33], v24 offset:12288
    ds_read_b64_tr_b16 v[34:35], v24 offset:12800
    s_waitcnt lgkmcnt(4)
    v_mfma_f32_32x32x16_bf16 v[176:191], v[44:47], v[160:163], v[176:191]
    ds_read_b64_tr_b16 v[36:37], v21 offset:12288
    ds_read_b64_tr_b16 v[38:39], v21 offset:12800
    v_mfma_f32_32x32x16_bf16 v[192:207], v[48:51], v[160:163], v[192:207]
    ds_read_b64_tr_b16 v[40:41], v25 offset:12288
    ds_read_b64_tr_b16 v[42:43], v25 offset:12800
    s_waitcnt lgkmcnt(4)
    v_mfma_f32_32x32x16_bf16 v[176:191], v[28:31], v[164:167], v[176:191]
    ds_read_b64_tr_b16 v[44:45], v22 offset:12288
    ds_read_b64_tr_b16 v[46:47], v22 offset:12800
    v_mfma_f32_32x32x16_bf16 v[192:207], v[32:35], v[164:167], v[192:207]
    ds_read_b64_tr_b16 v[48:49], v26 offset:12288
    ds_read_b64_tr_b16 v[50:51], v26 offset:12800
    s_waitcnt lgkmcnt(4)
    v_mfma_f32_32x32x16_bf16 v[176:191], v[36:39], v[168:171], v[176:191]
    ds_read_b64_tr_b16 v[28:29], v23 offset:12288
    ds_read_b64_tr_b16 v[30:31], v23 offset:12800
    v_mfma_f32_32x32x16_bf16 v[192:207], v[40:43], v[168:171], v[192:207]
    ds_read_b64_tr_b16 v[32:33], v27 offset:12288
    ds_read_b64_tr_b16 v[34:35], v27 offset:12800
    s_waitcnt lgkmcnt(4)
    v_mfma_f32_32x32x16_bf16 v[176:191], v[44:47], v[172:175], v[176:191]
    ds_read_b64_tr_b16 v[36:37], v20 offset:14336
    ds_read_b64_tr_b16 v[38:39], v20 offset:14848
    v_mfma_f32_32x32x16_bf16 v[192:207], v[48:51], v[172:175], v[192:207]
    ds_read_b64_tr_b16 v[40:41], v24 offset:14336
    ds_read_b64_tr_b16 v[42:43], v24 offset:14848
    s_waitcnt lgkmcnt(4)
    v_mfma_f32_32x32x16_bf16 v[176:191], v[28:31], v[236:239], v[176:191]
    ds_read_b64_tr_b16 v[44:45], v21 offset:14336
    ds_read_b64_tr_b16 v[46:47], v21 offset:14848
    s_waitcnt vmcnt(0)
    buffer_store_dword v8, v9, s[36:39], 0 offen sc1
    v_mov_b32 v8, 3
    v_mfma_f32_32x32x16_bf16 v[192:207], v[32:35], v[236:239], v[192:207]
    ds_read_b64_tr_b16 v[48:49], v25 offset:14336
    ds_read_b64_tr_b16 v[50:51], v25 offset:14848
    s_waitcnt lgkmcnt(4)
    v_mfma_f32_32x32x16_bf16 v[176:191], v[36:39], v[240:243], v[176:191]
    ds_read_b64_tr_b16 v[28:29], v22 offset:14336
    ds_read_b64_tr_b16 v[30:31], v22 offset:14848
    v_mfma_f32_32x32x16_bf16 v[192:207], v[40:43], v[240:243], v[192:207]
    ds_read_b64_tr_b16 v[32:33], v26 offset:14336
    ds_read_b64_tr_b16 v[34:35], v26 offset:14848
    s_waitcnt lgkmcnt(4)
    v_mfma_f32_32x32x16_bf16 v[176:191], v[44:47], v[244:247], v[176:191]
    ds_read_b64_tr_b16 v[36:37], v23 offset:14336
    ds_read_b64_tr_b16 v[38:39], v23 offset:14848
    v_mfma_f32_32x32x16_bf16 v[192:207], v[48:51], v[244:247], v[192:207]
    ds_read_b64_tr_b16 v[40:41], v27 offset:14336
    ds_read_b64_tr_b16 v[42:43], v27 offset:14848
    s_waitcnt lgkmcnt(4)
    v_mfma_f32_32x32x16_bf16 v[176:191], v[28:31], v[248:251], v[176:191]
    ds_read_b64_tr_b16 v[44:45], v20 offset:16384
    ds_read_b64_tr_b16 v[46:47], v20 offset:16896
    v_mfma_f32_32x32x16_bf16 v[192:207], v[32:35], v[248:251], v[192:207]
    ds_read_b64_tr_b16 v[48:49], v24 offset:16384
    ds_read_b64_tr_b16 v[50:51], v24 offset:16896
    s_waitcnt lgkmcnt(4)
    v_mfma_f32_32x32x16_bf16 v[176:191], v[36:39], v[252:255], v[176:191]
    ds_read_b64_tr_b16 v[28:29], v21 offset:16384
    ds_read_b64_tr_b16 v[30:31], v21 offset:16896
    v_mfma_f32_32x32x16_bf16 v[192:207], v[40:43], v[252:255], v[192:207]
    ds_read_b64_tr_b16 v[32:33], v25 offset:16384
    ds_read_b64_tr_b16 v[34:35], v25 offset:16896
    s_waitcnt lgkmcnt(4)
    v_mfma_f32_32x32x16_bf16 v[52:67], v[216:219], v[222:225], 0
    s_add_u32 s53, s53, 32768
    v_mfma_f32_32x32x16_bf16 v[68:83], v[218:221], v[222:225], 0
    v_mfma_f32_32x32x16_bf16 v[52:67], v[44:47], v[84:87], v[52:67]
    ds_read_b64_tr_b16 v[36:37], v22 offset:16384
    ds_read_b64_tr_b16 v[38:39], v22 offset:16896
    v_mfma_f32_32x32x16_bf16 v[68:83], v[48:51], v[84:87], v[68:83]
    ds_read_b64_tr_b16 v[40:41], v26 offset:16384
    ds_read_b64_tr_b16 v[42:43], v26 offset:16896
    v_mul_f32_e64 v176, v176, |v176|
    v_mul_f32_e64 v177, v177, |v177|
    v_cvt_pk_bf16_f32 v176, v176, v177
    v_pk_max_i16 v176, v176, 0
    v_mul_f32_e64 v178, v178, |v178|
    s_waitcnt lgkmcnt(4)
    v_mfma_f32_32x32x16_bf16 v[52:67], v[28:31], v[88:91], v[52:67]
    ds_read_b64_tr_b16 v[44:45], v23 offset:16384
    ds_read_b64_tr_b16 v[46:47], v23 offset:16896
    v_mul_f32_e64 v179, v179, |v179|
    v_cvt_pk_bf16_f32 v177, v178, v179
    v_pk_max_i16 v177, v177, 0
    v_mul_f32_e64 v180, v180, |v180|
    v_mul_f32_e64 v181, v181, |v181|
    v_cvt_pk_bf16_f32 v178, v180, v181
    v_mfma_f32_32x32x16_bf16 v[68:83], v[32:35], v[88:91], v[68:83]
    ds_read_b64_tr_b16 v[48:49], v27 offset:16384
    ds_read_b64_tr_b16 v[50:51], v27 offset:16896
    v_pk_max_i16 v178, v178, 0
    v_mul_f32_e64 v182, v182, |v182|
    v_mul_f32_e64 v183, v183, |v183|
    v_cvt_pk_bf16_f32 v179, v182, v183
    v_pk_max_i16 v179, v179, 0
    s_waitcnt lgkmcnt(4)
    v_mfma_f32_32x32x16_bf16 v[52:67], v[36:39], v[92:95], v[52:67]
    ds_read_b64_tr_b16 v[28:29], v20 offset:18432
    ds_read_b64_tr_b16 v[30:31], v20 offset:18944
    buffer_store_dwordx4 v[176:179], v18, s[36:39], s53 offen offset:0 sc1
    v_mul_f32_e64 v184, v184, |v184|
    v_mul_f32_e64 v185, v185, |v185|
    v_cvt_pk_bf16_f32 v180, v184, v185
    v_pk_max_i16 v180, v180, 0
    v_mul_f32_e64 v186, v186, |v186|
    v_mfma_f32_32x32x16_bf16 v[68:83], v[40:43], v[92:95], v[68:83]
    ds_read_b64_tr_b16 v[32:33], v24 offset:18432
    ds_read_b64_tr_b16 v[34:35], v24 offset:18944
    v_mul_f32_e64 v187, v187, |v187|
    v_cvt_pk_bf16_f32 v181, v186, v187
    v_pk_max_i16 v181, v181, 0
    v_mul_f32_e64 v188, v188, |v188|
    v_mul_f32_e64 v189, v189, |v189|
    s_waitcnt lgkmcnt(4)
    v_mfma_f32_32x32x16_bf16 v[52:67], v[44:47], v[96:99], v[52:67]
    ds_read_b64_tr_b16 v[36:37], v21 offset:18432
    ds_read_b64_tr_b16 v[38:39], v21 offset:18944
    v_cvt_pk_bf16_f32 v182, v188, v189
    v_pk_max_i16 v182, v182, 0
    v_mul_f32_e64 v190, v190, |v190|
    v_mul_f32_e64 v191, v191, |v191|
    v_cvt_pk_bf16_f32 v183, v190, v191
    v_pk_max_i16 v183, v183, 0
    v_mfma_f32_32x32x16_bf16 v[68:83], v[48:51], v[96:99], v[68:83]
    ds_read_b64_tr_b16 v[40:41], v25 offset:18432
    ds_read_b64_tr_b16 v[42:43], v25 offset:18944
    buffer_store_dwordx4 v[180:183], v18, s[36:39], s53 offen offset:1024 sc1
    v_mul_f32_e64 v192, v192, |v192|
    v_mul_f32_e64 v193, v193, |v193|
    v_cvt_pk_bf16_f32 v192, v192, v193
    v_pk_max_i16 v192, v192, 0
    s_waitcnt lgkmcnt(4)
    v_mfma_f32_32x32x16_bf16 v[52:67], v[28:31], v[100:103], v[52:67]
    s_barrier
    ds_read_b64_tr_b16 v[44:45], v22 offset:18432
    ds_read_b64_tr_b16 v[46:47], v22 offset:18944
    v_mul_f32_e64 v194, v194, |v194|
    v_mul_f32_e64 v195, v195, |v195|
    v_cvt_pk_bf16_f32 v193, v194, v195
    v_pk_max_i16 v193, v193, 0
    v_mul_f32_e64 v196, v196, |v196|
    v_mul_f32_e64 v197, v197, |v197|
    v_mfma_f32_32x32x16_bf16 v[68:83], v[32:35], v[100:103], v[68:83]
    ds_read_b64_tr_b16 v[48:49], v26 offset:18432
    ds_read_b64_tr_b16 v[50:51], v26 offset:18944
    v_cvt_pk_bf16_f32 v194, v196, v197
    v_pk_max_i16 v194, v194, 0
    v_mul_f32_e64 v198, v198, |v198|
    v_mul_f32_e64 v199, v199, |v199|
    v_cvt_pk_bf16_f32 v195, v198, v199
    s_waitcnt lgkmcnt(4)
    v_mfma_f32_32x32x16_bf16 v[52:67], v[36:39], v[104:107], v[52:67]
    ds_read_b64_tr_b16 v[28:29], v23 offset:18432
    ds_read_b64_tr_b16 v[30:31], v23 offset:18944
    v_pk_max_i16 v195, v195, 0
    buffer_store_dwordx4 v[192:195], v18, s[36:39], s53 offen offset:2048 sc1
    v_mul_f32_e64 v200, v200, |v200|
    v_mul_f32_e64 v201, v201, |v201|
    v_cvt_pk_bf16_f32 v196, v200, v201
    v_pk_max_i16 v196, v196, 0
    v_mfma_f32_32x32x16_bf16 v[68:83], v[40:43], v[104:107], v[68:83]
    ds_read_b64_tr_b16 v[32:33], v27 offset:18432
    ds_read_b64_tr_b16 v[34:35], v27 offset:18944
    v_mul_f32_e64 v202, v202, |v202|
    v_mul_f32_e64 v203, v203, |v203|
    v_cvt_pk_bf16_f32 v197, v202, v203
    v_pk_max_i16 v197, v197, 0
    v_mul_f32_e64 v204, v204, |v204|
    s_waitcnt lgkmcnt(4)
    v_mfma_f32_32x32x16_bf16 v[52:67], v[44:47], v[108:111], v[52:67]
    ds_read_b64_tr_b16 v[36:37], v20 offset:20480
    ds_read_b64_tr_b16 v[38:39], v20 offset:20992
    v_mul_f32_e64 v205, v205, |v205|
    v_cvt_pk_bf16_f32 v198, v204, v205
    v_pk_max_i16 v198, v198, 0
    v_mul_f32_e64 v206, v206, |v206|
    v_mul_f32_e64 v207, v207, |v207|
    v_cvt_pk_bf16_f32 v199, v206, v207
    v_mfma_f32_32x32x16_bf16 v[68:83], v[48:51], v[108:111], v[68:83]
    ds_read_b64_tr_b16 v[40:41], v24 offset:20480
    ds_read_b64_tr_b16 v[42:43], v24 offset:20992
    v_pk_max_i16 v199, v199, 0
    buffer_store_dwordx4 v[196:199], v18, s[36:39], s53 offen offset:3072 sc1
    s_waitcnt lgkmcnt(4)
    v_mfma_f32_32x32x16_bf16 v[52:67], v[28:31], v[112:115], v[52:67]
    ds_read_b64_tr_b16 v[44:45], v21 offset:20480
    ds_read_b64_tr_b16 v[46:47], v21 offset:20992
    v_mfma_f32_32x32x16_bf16 v[68:83], v[32:35], v[112:115], v[68:83]
    ds_read_b64_tr_b16 v[48:49], v25 offset:20480
    ds_read_b64_tr_b16 v[50:51], v25 offset:20992
    s_waitcnt lgkmcnt(4)
    v_mfma_f32_32x32x16_bf16 v[52:67], v[36:39], v[116:119], v[52:67]
    ds_read_b64_tr_b16 v[28:29], v22 offset:20480
    ds_read_b64_tr_b16 v[30:31], v22 offset:20992
    v_mfma_f32_32x32x16_bf16 v[68:83], v[40:43], v[116:119], v[68:83]
    ds_read_b64_tr_b16 v[32:33], v26 offset:20480
    ds_read_b64_tr_b16 v[34:35], v26 offset:20992
    s_waitcnt lgkmcnt(4)
    v_mfma_f32_32x32x16_bf16 v[52:67], v[44:47], v[120:123], v[52:67]
    ds_read_b64_tr_b16 v[36:37], v23 offset:20480
    ds_read_b64_tr_b16 v[38:39], v23 offset:20992
    v_mfma_f32_32x32x16_bf16 v[68:83], v[48:51], v[120:123], v[68:83]
    ds_read_b64_tr_b16 v[40:41], v27 offset:20480
    ds_read_b64_tr_b16 v[42:43], v27 offset:20992
    s_waitcnt lgkmcnt(4)
    v_mfma_f32_32x32x16_bf16 v[52:67], v[28:31], v[124:127], v[52:67]
    ds_read_b64_tr_b16 v[44:45], v20 offset:22528
    ds_read_b64_tr_b16 v[46:47], v20 offset:23040
    v_mfma_f32_32x32x16_bf16 v[68:83], v[32:35], v[124:127], v[68:83]
    ds_read_b64_tr_b16 v[48:49], v24 offset:22528
    ds_read_b64_tr_b16 v[50:51], v24 offset:23040
    s_waitcnt lgkmcnt(4)
    v_mfma_f32_32x32x16_bf16 v[52:67], v[36:39], v[128:131], v[52:67]
    ds_read_b64_tr_b16 v[28:29], v21 offset:22528
    ds_read_b64_tr_b16 v[30:31], v21 offset:23040
    v_mfma_f32_32x32x16_bf16 v[68:83], v[40:43], v[128:131], v[68:83]
    ds_read_b64_tr_b16 v[32:33], v25 offset:22528
    ds_read_b64_tr_b16 v[34:35], v25 offset:23040
    s_waitcnt lgkmcnt(4)
    v_mfma_f32_32x32x16_bf16 v[52:67], v[44:47], v[132:135], v[52:67]
    ds_read_b64_tr_b16 v[36:37], v22 offset:22528
    ds_read_b64_tr_b16 v[38:39], v22 offset:23040
    v_mfma_f32_32x32x16_bf16 v[68:83], v[48:51], v[132:135], v[68:83]
    ds_read_b64_tr_b16 v[40:41], v26 offset:22528
    ds_read_b64_tr_b16 v[42:43], v26 offset:23040
    s_waitcnt lgkmcnt(4)
    v_mfma_f32_32x32x16_bf16 v[52:67], v[28:31], v[136:139], v[52:67]
    ds_read_b64_tr_b16 v[44:45], v23 offset:22528
    ds_read_b64_tr_b16 v[46:47], v23 offset:23040
    v_mfma_f32_32x32x16_bf16 v[68:83], v[32:35], v[136:139], v[68:83]
    ds_read_b64_tr_b16 v[48:49], v27 offset:22528
    ds_read_b64_tr_b16 v[50:51], v27 offset:23040
    s_waitcnt lgkmcnt(4)
    v_mfma_f32_32x32x16_bf16 v[52:67], v[36:39], v[140:143], v[52:67]
    ds_read_b64_tr_b16 v[28:29], v20 offset:24576
    ds_read_b64_tr_b16 v[30:31], v20 offset:25088
    v_mfma_f32_32x32x16_bf16 v[68:83], v[40:43], v[140:143], v[68:83]
    ds_read_b64_tr_b16 v[32:33], v24 offset:24576
    ds_read_b64_tr_b16 v[34:35], v24 offset:25088
    s_waitcnt lgkmcnt(4)
    v_mfma_f32_32x32x16_bf16 v[52:67], v[44:47], v[144:147], v[52:67]
    ds_read_b64_tr_b16 v[36:37], v21 offset:24576
    ds_read_b64_tr_b16 v[38:39], v21 offset:25088
    v_mfma_f32_32x32x16_bf16 v[68:83], v[48:51], v[144:147], v[68:83]
    ds_read_b64_tr_b16 v[40:41], v25 offset:24576
    ds_read_b64_tr_b16 v[42:43], v25 offset:25088
    s_waitcnt lgkmcnt(4)
    v_mfma_f32_32x32x16_bf16 v[52:67], v[28:31], v[148:151], v[52:67]
    ds_read_b64_tr_b16 v[44:45], v22 offset:24576
    ds_read_b64_tr_b16 v[46:47], v22 offset:25088
    v_mfma_f32_32x32x16_bf16 v[68:83], v[32:35], v[148:151], v[68:83]
    ds_read_b64_tr_b16 v[48:49], v26 offset:24576
    ds_read_b64_tr_b16 v[50:51], v26 offset:25088
    s_waitcnt lgkmcnt(4)
    v_mfma_f32_32x32x16_bf16 v[52:67], v[36:39], v[152:155], v[52:67]
    ds_read_b64_tr_b16 v[28:29], v23 offset:24576
    ds_read_b64_tr_b16 v[30:31], v23 offset:25088
    v_mfma_f32_32x32x16_bf16 v[68:83], v[40:43], v[152:155], v[68:83]
    ds_read_b64_tr_b16 v[32:33], v27 offset:24576
    ds_read_b64_tr_b16 v[34:35], v27 offset:25088
    s_waitcnt lgkmcnt(4)
    v_mfma_f32_32x32x16_bf16 v[52:67], v[44:47], v[156:159], v[52:67]
    ds_read_b64_tr_b16 v[36:37], v20 offset:26624
    ds_read_b64_tr_b16 v[38:39], v20 offset:27136
    v_mfma_f32_32x32x16_bf16 v[68:83], v[48:51], v[156:159], v[68:83]
    ds_read_b64_tr_b16 v[40:41], v24 offset:26624
    ds_read_b64_tr_b16 v[42:43], v24 offset:27136
    s_waitcnt lgkmcnt(4)
    v_mfma_f32_32x32x16_bf16 v[52:67], v[28:31], v[160:163], v[52:67]
    ds_read_b64_tr_b16 v[44:45], v21 offset:26624
    ds_read_b64_tr_b16 v[46:47], v21 offset:27136
    v_mfma_f32_32x32x16_bf16 v[68:83], v[32:35], v[160:163], v[68:83]
    ds_read_b64_tr_b16 v[48:49], v25 offset:26624
    ds_read_b64_tr_b16 v[50:51], v25 offset:27136
    s_waitcnt vmcnt(0)
    buffer_store_dword v8, v9, s[36:39], 0 offen sc1
    v_mov_b32 v8, 7
    s_waitcnt lgkmcnt(4)
    v_mfma_f32_32x32x16_bf16 v[52:67], v[36:39], v[164:167], v[52:67]
    ds_read_b64_tr_b16 v[28:29], v22 offset:26624
    ds_read_b64_tr_b16 v[30:31], v22 offset:27136
    v_mfma_f32_32x32x16_bf16 v[68:83], v[40:43], v[164:167], v[68:83]
    ds_read_b64_tr_b16 v[32:33], v26 offset:26624
    ds_read_b64_tr_b16 v[34:35], v26 offset:27136
    s_waitcnt lgkmcnt(4)
    v_mfma_f32_32x32x16_bf16 v[52:67], v[44:47], v[168:171], v[52:67]
    ds_read_b64_tr_b16 v[36:37], v23 offset:26624
    ds_read_b64_tr_b16 v[38:39], v23 offset:27136
    v_mfma_f32_32x32x16_bf16 v[68:83], v[48:51], v[168:171], v[68:83]
    ds_read_b64_tr_b16 v[40:41], v27 offset:26624
    ds_read_b64_tr_b16 v[42:43], v27 offset:27136
    s_waitcnt lgkmcnt(4)
    v_mfma_f32_32x32x16_bf16 v[52:67], v[28:31], v[172:175], v[52:67]
    ds_read_b64_tr_b16 v[44:45], v20 offset:28672
    ds_read_b64_tr_b16 v[46:47], v20 offset:29184
    v_mfma_f32_32x32x16_bf16 v[68:83], v[32:35], v[172:175], v[68:83]
    ds_read_b64_tr_b16 v[48:49], v24 offset:28672
    ds_read_b64_tr_b16 v[50:51], v24 offset:29184
    s_waitcnt lgkmcnt(4)
    v_mfma_f32_32x32x16_bf16 v[52:67], v[36:39], v[236:239], v[52:67]
    ds_read_b64_tr_b16 v[28:29], v21 offset:28672
    ds_read_b64_tr_b16 v[30:31], v21 offset:29184
    v_mfma_f32_32x32x16_bf16 v[68:83], v[40:43], v[236:239], v[68:83]
    ds_read_b64_tr_b16 v[32:33], v25 offset:28672
    ds_read_b64_tr_b16 v[34:35], v25 offset:29184
    s_waitcnt lgkmcnt(4)
    v_mfma_f32_32x32x16_bf16 v[52:67], v[44:47], v[240:243], v[52:67]
    ds_read_b64_tr_b16 v[36:37], v22 offset:28672
    ds_read_b64_tr_b16 v[38:39], v22 offset:29184
    v_mfma_f32_32x32x16_bf16 v[68:83], v[48:51], v[240:243], v[68:83]
    ds_read_b64_tr_b16 v[40:41], v26 offset:28672
    ds_read_b64_tr_b16 v[42:43], v26 offset:29184
    s_waitcnt lgkmcnt(4)
    v_mfma_f32_32x32x16_bf16 v[52:67], v[28:31], v[244:247], v[52:67]
    ds_read_b64_tr_b16 v[44:45], v23 offset:28672
    ds_read_b64_tr_b16 v[46:47], v23 offset:29184
    v_mfma_f32_32x32x16_bf16 v[68:83], v[32:35], v[244:247], v[68:83]
    ds_read_b64_tr_b16 v[48:49], v27 offset:28672
    ds_read_b64_tr_b16 v[50:51], v27 offset:29184
    s_waitcnt lgkmcnt(4)
    v_mfma_f32_32x32x16_bf16 v[52:67], v[36:39], v[248:251], v[52:67]
    ds_read_b64_tr_b16 v[28:29], v14 offset:30720
    ds_read_b64_tr_b16 v[30:31], v14 offset:30976
    v_mfma_f32_32x32x16_bf16 v[68:83], v[40:43], v[248:251], v[68:83]
    ds_read_b64_tr_b16 v[32:33], v15 offset:30720
    ds_read_b64_tr_b16 v[34:35], v15 offset:30976
    s_waitcnt lgkmcnt(4)
    v_mfma_f32_32x32x16_bf16 v[52:67], v[44:47], v[252:255], v[52:67]
    ds_read_b64_tr_b16 v[36:37], v16 offset:30720
    ds_read_b64_tr_b16 v[38:39], v16 offset:30976
    v_mfma_f32_32x32x16_bf16 v[68:83], v[48:51], v[252:255], v[68:83]
    ds_read_b64_tr_b16 v[40:41], v17 offset:30720
    ds_read_b64_tr_b16 v[42:43], v17 offset:30976
    s_waitcnt lgkmcnt(4)
    v_mfma_f32_32x32x16_bf16 v[176:191], v[220:223], v[222:225], 0
    s_add_u32 s53, s53, 32768
    v_mfma_f32_32x32x16_bf16 v[176:191], v[28:31], v[84:87], v[176:191]
    ds_read_b64_tr_b16 v[44:45], v14 offset:31744
    ds_read_b64_tr_b16 v[46:47], v14 offset:32000
    v_mfma_f32_32x32x16_bf16 v[176:191], v[32:35], v[88:91], v[176:191]
    ds_read_b64_tr_b16 v[48:49], v15 offset:31744
    ds_read_b64_tr_b16 v[50:51], v15 offset:32000
    s_waitcnt lgkmcnt(4)
    v_mfma_f32_32x32x16_bf16 v[176:191], v[36:39], v[92:95], v[176:191]
    ds_read_b64_tr_b16 v[28:29], v16 offset:31744
    ds_read_b64_tr_b16 v[30:31], v16 offset:32000
    v_mul_f32_e64 v52, v52, |v52|
    v_mul_f32_e64 v53, v53, |v53|
    v_cvt_pk_bf16_f32 v52, v52, v53
    v_pk_max_i16 v52, v52, 0
    v_mul_f32_e64 v54, v54, |v54|
    v_mul_f32_e64 v55, v55, |v55|
    v_mfma_f32_32x32x16_bf16 v[176:191], v[40:43], v[96:99], v[176:191]
    ds_read_b64_tr_b16 v[32:33], v17 offset:31744
    ds_read_b64_tr_b16 v[34:35], v17 offset:32000
    v_cvt_pk_bf16_f32 v53, v54, v55
    v_pk_max_i16 v53, v53, 0
    v_mul_f32_e64 v56, v56, |v56|
    v_mul_f32_e64 v57, v57, |v57|
    v_cvt_pk_bf16_f32 v54, v56, v57
    s_waitcnt lgkmcnt(4)
    v_mfma_f32_32x32x16_bf16 v[176:191], v[44:47], v[100:103], v[176:191]
    ds_read_b64_tr_b16 v[36:37], v14 offset:32768
    ds_read_b64_tr_b16 v[38:39], v14 offset:33024
    v_pk_max_i16 v54, v54, 0
    v_mul_f32_e64 v58, v58, |v58|
    v_mul_f32_e64 v59, v59, |v59|
    v_cvt_pk_bf16_f32 v55, v58, v59
    v_pk_max_i16 v55, v55, 0
    buffer_store_dwordx4 v[52:55], v18, s[36:39], s53 offen offset:0 sc1
    v_mfma_f32_32x32x16_bf16 v[176:191], v[48:51], v[104:107], v[176:191]
    ds_read_b64_tr_b16 v[40:41], v15 offset:32768
    ds_read_b64_tr_b16 v[42:43], v15 offset:33024
    v_mul_f32_e64 v60, v60, |v60|
    v_mul_f32_e64 v61, v61, |v61|
    v_cvt_pk_bf16_f32 v56, v60, v61
    v_pk_max_i16 v56, v56, 0
    v_mul_f32_e64 v62, v62, |v62|
    s_waitcnt lgkmcnt(4)
    v_mfma_f32_32x32x16_bf16 v[176:191], v[28:31], v[108:111], v[176:191]
    ds_read_b64_tr_b16 v[44:45], v16 offset:32768
    ds_read_b64_tr_b16 v[46:47], v16 offset:33024
    v_mul_f32_e64 v63, v63, |v63|
    v_cvt_pk_bf16_f32 v57, v62, v63
    v_pk_max_i16 v57, v57, 0
    v_mul_f32_e64 v64, v64, |v64|
    v_mul_f32_e64 v65, v65, |v65|
    v_cvt_pk_bf16_f32 v58, v64, v65
    v_mfma_f32_32x32x16_bf16 v[176:191], v[32:35], v[112:115], v[176:191]
    ds_read_b64_tr_b16 v[48:49], v17 offset:32768
    ds_read_b64_tr_b16 v[50:51], v17 offset:33024
    v_pk_max_i16 v58, v58, 0
    v_mul_f32_e64 v66, v66, |v66|
    v_mul_f32_e64 v67, v67, |v67|
    v_cvt_pk_bf16_f32 v59, v66, v67
    v_pk_max_i16 v59, v59, 0
    s_waitcnt lgkmcnt(4)
    v_mfma_f32_32x32x16_bf16 v[176:191], v[36:39], v[116:119], v[176:191]
    ds_read_b64_tr_b16 v[28:29], v14 offset:33792
    ds_read_b64_tr_b16 v[30:31], v14 offset:34048
    buffer_store_dwordx4 v[56:59], v18, s[36:39], s53 offen offset:1024 sc1
    v_mul_f32_e64 v68, v68, |v68|
    v_mul_f32_e64 v69, v69, |v69|
    v_cvt_pk_bf16_f32 v68, v68, v69
    v_pk_max_i16 v68, v68, 0
    v_mul_f32_e64 v70, v70, |v70|
    v_mfma_f32_32x32x16_bf16 v[176:191], v[40:43], v[120:123], v[176:191]
    ds_read_b64_tr_b16 v[32:33], v15 offset:33792
    ds_read_b64_tr_b16 v[34:35], v15 offset:34048
    v_mul_f32_e64 v71, v71, |v71|
    v_cvt_pk_bf16_f32 v69, v70, v71
    v_pk_max_i16 v69, v69, 0
    v_mul_f32_e64 v72, v72, |v72|
    v_mul_f32_e64 v73, v73, |v73|
    s_waitcnt lgkmcnt(4)
    v_mfma_f32_32x32x16_bf16 v[176:191], v[44:47], v[124:127], v[176:191]
    ds_read_b64_tr_b16 v[36:37], v16 offset:33792
    ds_read_b64_tr_b16 v[38:39], v16 offset:34048
    v_cvt_pk_bf16_f32 v70, v72, v73
    v_pk_max_i16 v70, v70, 0
    v_mul_f32_e64 v74, v74, |v74|
    v_mul_f32_e64 v75, v75, |v75|
    v_cvt_pk_bf16_f32 v71, v74, v75
    v_pk_max_i16 v71, v71, 0
    v_mfma_f32_32x32x16_bf16 v[176:191], v[48:51], v[128:131], v[176:191]
    ds_read_b64_tr_b16 v[40:41], v17 offset:33792
    ds_read_b64_tr_b16 v[42:43], v17 offset:34048
    buffer_store_dwordx4 v[68:71], v18, s[36:39], s53 offen offset:2048 sc1
    v_mul_f32_e64 v76, v76, |v76|
    v_mul_f32_e64 v77, v77, |v77|
    v_cvt_pk_bf16_f32 v72, v76, v77
    v_pk_max_i16 v72, v72, 0
    s_waitcnt lgkmcnt(4)
    v_mfma_f32_32x32x16_bf16 v[176:191], v[28:31], v[132:135], v[176:191]
    ds_read_b64_tr_b16 v[44:45], v14 offset:34816
    ds_read_b64_tr_b16 v[46:47], v14 offset:35072
    v_mul_f32_e64 v78, v78, |v78|
    v_mul_f32_e64 v79, v79, |v79|
    v_cvt_pk_bf16_f32 v73, v78, v79
    v_pk_max_i16 v73, v73, 0
    v_mul_f32_e64 v80, v80, |v80|
    v_mul_f32_e64 v81, v81, |v81|
    v_mfma_f32_32x32x16_bf16 v[176:191], v[32:35], v[136:139], v[176:191]
    ds_read_b64_tr_b16 v[48:49], v15 offset:34816
    ds_read_b64_tr_b16 v[50:51], v15 offset:35072
    v_cvt_pk_bf16_f32 v74, v80, v81
    v_pk_max_i16 v74, v74, 0
    v_mul_f32_e64 v82, v82, |v82|
    v_mul_f32_e64 v83, v83, |v83|
    v_cvt_pk_bf16_f32 v75, v82, v83
    s_waitcnt lgkmcnt(4)
    v_mfma_f32_32x32x16_bf16 v[176:191], v[36:39], v[140:143], v[176:191]
    ds_read_b64_tr_b16 v[28:29], v16 offset:34816
    ds_read_b64_tr_b16 v[30:31], v16 offset:35072
    v_pk_max_i16 v75, v75, 0
    buffer_store_dwordx4 v[72:75], v18, s[36:39], s53 offen offset:3072 sc1
    v_mfma_f32_32x32x16_bf16 v[176:191], v[40:43], v[144:147], v[176:191]
    ds_read_b64_tr_b16 v[32:33], v17 offset:34816
    ds_read_b64_tr_b16 v[34:35], v17 offset:35072
    s_waitcnt lgkmcnt(4)
    v_mfma_f32_32x32x16_bf16 v[176:191], v[44:47], v[148:151], v[176:191]
    ds_read_b64_tr_b16 v[36:37], v14 offset:35840
    ds_read_b64_tr_b16 v[38:39], v14 offset:36096
    v_mfma_f32_32x32x16_bf16 v[176:191], v[48:51], v[152:155], v[176:191]
    ds_read_b64_tr_b16 v[40:41], v15 offset:35840
    ds_read_b64_tr_b16 v[42:43], v15 offset:36096
    s_waitcnt lgkmcnt(4)
    v_mfma_f32_32x32x16_bf16 v[176:191], v[28:31], v[156:159], v[176:191]
    ds_read_b64_tr_b16 v[44:45], v16 offset:35840
    ds_read_b64_tr_b16 v[46:47], v16 offset:36096
    v_mfma_f32_32x32x16_bf16 v[176:191], v[32:35], v[160:163], v[176:191]
    ds_read_b64_tr_b16 v[48:49], v17 offset:35840
    ds_read_b64_tr_b16 v[50:51], v17 offset:36096
    s_waitcnt lgkmcnt(4)
    v_mfma_f32_32x32x16_bf16 v[176:191], v[36:39], v[164:167], v[176:191]
    ds_read_b64_tr_b16 v[28:29], v14 offset:36864
    ds_read_b64_tr_b16 v[30:31], v14 offset:37120
    v_mfma_f32_32x32x16_bf16 v[176:191], v[40:43], v[168:171], v[176:191]
    ds_read_b64_tr_b16 v[32:33], v15 offset:36864
    ds_read_b64_tr_b16 v[34:35], v15 offset:37120
    s_waitcnt lgkmcnt(4)
    v_mfma_f32_32x32x16_bf16 v[176:191], v[44:47], v[172:175], v[176:191]
    ds_read_b64_tr_b16 v[36:37], v16 offset:36864
    ds_read_b64_tr_b16 v[38:39], v16 offset:37120
    v_mfma_f32_32x32x16_bf16 v[176:191], v[48:51], v[236:239], v[176:191]
    ds_read_b64_tr_b16 v[40:41], v17 offset:36864
    ds_read_b64_tr_b16 v[42:43], v17 offset:37120
    s_waitcnt lgkmcnt(4)
    v_mfma_f32_32x32x16_bf16 v[176:191], v[28:31], v[240:243], v[176:191]
    v_mfma_f32_32x32x16_bf16 v[176:191], v[32:35], v[244:247], v[176:191]
    s_waitcnt lgkmcnt(0)
    v_mfma_f32_32x32x16_bf16 v[176:191], v[36:39], v[248:251], v[176:191]
    v_mfma_f32_32x32x16_bf16 v[176:191], v[40:43], v[252:255], v[176:191]
    s_nop 11
    v_mul_f32_e64 v176, v176, |v176|
    v_mul_f32_e64 v177, v177, |v177|
    v_cvt_pk_bf16_f32 v176, v176, v177
    v_pk_max_i16 v176, v176, 0
    v_mul_f32_e64 v178, v178, |v178|
    v_mul_f32_e64 v179, v179, |v179|
    v_cvt_pk_bf16_f32 v177, v178, v179
    v_pk_max_i16 v177, v177, 0
    v_mul_f32_e64 v180, v180, |v180|
    v_mul_f32_e64 v181, v181, |v181|
    v_cvt_pk_bf16_f32 v178, v180, v181
    v_pk_max_i16 v178, v178, 0
    v_mul_f32_e64 v182, v182, |v182|
    v_mul_f32_e64 v183, v183, |v183|
    v_cvt_pk_bf16_f32 v179, v182, v183
    v_pk_max_i16 v179, v179, 0
    buffer_store_dwordx4 v[176:179], v18, s[36:39], s57 offen offset:0 sc1
    v_mul_f32_e64 v184, v184, |v184|
    v_mul_f32_e64 v185, v185, |v185|
    v_cvt_pk_bf16_f32 v180, v184, v185
    v_pk_max_i16 v180, v180, 0
    v_mul_f32_e64 v186, v186, |v186|
    v_mul_f32_e64 v187, v187, |v187|
    v_cvt_pk_bf16_f32 v181, v186, v187
    v_pk_max_i16 v181, v181, 0
    v_mul_f32_e64 v188, v188, |v188|
    v_mul_f32_e64 v189, v189, |v189|
    v_cvt_pk_bf16_f32 v182, v188, v189
    v_pk_max_i16 v182, v182, 0
    v_mul_f32_e64 v190, v190, |v190|
    v_mul_f32_e64 v191, v191, |v191|
    v_cvt_pk_bf16_f32 v183, v190, v191
    v_pk_max_i16 v183, v183, 0
    buffer_store_dwordx4 v[180:183], v18, s[36:39], s57 offen offset:1024 sc1
    s_waitcnt vmcnt(2)
    buffer_store_dword v8, v9, s[36:39], 0 offen sc1
    v_mov_b32 v8, 15
    s_waitcnt vmcnt(1)
    buffer_store_dword v8, v9, s[36:39], 0 offen sc1
    s_branch L_amid
L_Ak:
    s_waitcnt lgkmcnt(6)
    v_mfma_f32_32x32x16_bf16 v[52:67], v[84:87], v[28:31], 0
    ds_read_b64_tr_b16 v[44:45], v22 offset:28672
    ds_read_b64_tr_b16 v[46:47], v22 offset:29184
    v_lshlrev_b32 v7, 16, v236
    v_and_b32 v19, s10, v236
    v_fma_f32 v7, v7, v2, v3
    v_fma_f32 v19, v19, v2, v3
    s_waitcnt lgkmcnt(6)
    v_mfma_f32_32x32x16_bf16 v[68:83], v[84:87], v[32:35], 0
    ds_read_b64_tr_b16 v[48:49], v26 offset:28672
    ds_read_b64_tr_b16 v[50:51], v26 offset:29184
    v_cvt_pk_bf16_f32 v236, v7, v19
    v_lshlrev_b32 v1, 16, v237
    v_and_b32 v4, s10, v237
    s_waitcnt lgkmcnt(4)
    v_mfma_f32_32x32x16_bf16 v[52:67], v[88:91], v[36:39], v[52:67]
    ds_read_b64_tr_b16 v[28:29], v23 offset:28672
    ds_read_b64_tr_b16 v[30:31], v23 offset:29184
    v_fma_f32 v1, v1, v2, v3
    v_fma_f32 v4, v4, v2, v3
    v_cvt_pk_bf16_f32 v237, v1, v4
    v_lshlrev_b32 v7, 16, v238
    v_mfma_f32_32x32x16_bf16 v[68:83], v[88:91], v[40:43], v[68:83]
    ds_read_b64_tr_b16 v[32:33], v27 offset:28672
    ds_read_b64_tr_b16 v[34:35], v27 offset:29184
    v_and_b32 v19, s10, v238
    v_fma_f32 v7, v7, v2, v3
    v_fma_f32 v19, v19, v2, v3
    s_waitcnt lgkmcnt(4)
    v_mfma_f32_32x32x16_bf16 v[52:67], v[92:95], v[44:47], v[52:67]
    s_barrier
    ds_read_b64_tr_b16 v[36:37], v20 offset:30720
    ds_read_b64_tr_b16 v[38:39], v20 offset:31232
    v_cvt_pk_bf16_f32 v238, v7, v19
    v_lshlrev_b32 v1, 16, v239
    v_and_b32 v4, s10, v239
    v_fma_f32 v1, v1, v2, v3
    v_mfma_f32_32x32x16_bf16 v[68:83], v[92:95], v[48:51], v[68:83]
    ds_read_b64_tr_b16 v[40:41], v24 offset:30720
    ds_read_b64_tr_b16 v[42:43], v24 offset:31232
    v_fma_f32 v4, v4, v2, v3
    v_cvt_pk_bf16_f32 v239, v1, v4
    v_lshlrev_b32 v7, 16, v240
    s_waitcnt lgkmcnt(4)
    v_mfma_f32_32x32x16_bf16 v[52:67], v[96:99], v[28:31], v[52:67]
    ds_read_b64_tr_b16 v[44:45], v21 offset:30720
    ds_read_b64_tr_b16 v[46:47], v21 offset:31232
    v_and_b32 v19, s10, v240
    v_fma_f32 v7, v7, v2, v3
    v_fma_f32 v19, v19, v2, v3
    v_cvt_pk_bf16_f32 v240, v7, v19
    v_mfma_f32_32x32x16_bf16 v[68:83], v[96:99], v[32:35], v[68:83]
    ds_read_b64_tr_b16 v[48:49], v25 offset:30720
    ds_read_b64_tr_b16 v[50:51], v25 offset:31232
    v_lshlrev_b32 v1, 16, v241
    v_and_b32 v4, s10, v241
    v_fma_f32 v1, v1, v2, v3
    s_waitcnt lgkmcnt(4)
    v_mfma_f32_32x32x16_bf16 v[52:67], v[100:103], v[36:39], v[52:67]
    ds_read_b64_tr_b16 v[28:29], v22 offset:30720
    ds_read_b64_tr_b16 v[30:31], v22 offset:31232
    v_fma_f32 v4, v4, v2, v3
    v_cvt_pk_bf16_f32 v241, v1, v4
    v_lshlrev_b32 v7, 16, v242
    v_and_b32 v19, s10, v242
    v_mfma_f32_32x32x16_bf16 v[68:83], v[100:103], v[40:43], v[68:83]
    ds_read_b64_tr_b16 v[32:33], v26 offset:30720
    ds_read_b64_tr_b16 v[34:35], v26 offset:31232
    v_fma_f32 v7, v7, v2, v3
    v_fma_f32 v19, v19, v2, v3
    v_cvt_pk_bf16_f32 v242, v7, v19
    s_waitcnt lgkmcnt(4)
    v_mfma_f32_32x32x16_bf16 v[52:67], v[104:107], v[44:47], v[52:67]
    ds_read_b64_tr_b16 v[36:37], v23 offset:30720
    ds_read_b64_tr_b16 v[38:39], v23 offset:31232
    v_lshlrev_b32 v1, 16, v243
    v_and_b32 v4, s10, v243
    v_fma_f32 v1, v1, v2, v3
    v_fma_f32 v4, v4, v2, v3
    v_mfma_f32_32x32x16_bf16 v[68:83], v[104:107], v[48:51], v[68:83]
    ds_read_b64_tr_b16 v[40:41], v27 offset:30720
    ds_read_b64_tr_b16 v[42:43], v27 offset:31232
    v_cvt_pk_bf16_f32 v243, v1, v4
    v_lshlrev_b32 v7, 16, v244
    v_and_b32 v19, s10, v244
    s_waitcnt lgkmcnt(4)
    v_mfma_f32_32x32x16_bf16 v[52:67], v[108:111], v[28:31], v[52:67]
    s_barrier
    ds_read_b64_tr_b16 v[44:45], v20 offset:32768
    ds_read_b64_tr_b16 v[46:47], v20 offset:33280
    v_fma_f32 v7, v7, v2, v3
    v_fma_f32 v19, v19, v2, v3
    v_cvt_pk_bf16_f32 v116, v116, v117
    v_cvt_pk_bf16_f32 v117, v118, v119
    v_mfma_f32_32x32x16_bf16 v[68:83], v[108:111], v[32:35], v[68:83]
    ds_read_b64_tr_b16 v[48:49], v24 offset:32768
    ds_read_b64_tr_b16 v[50:51], v24 offset:33280
    v_cvt_pk_bf16_f32 v244, v7, v19
    v_cvt_pk_bf16_f32 v118, v120, v121
    v_cvt_pk_bf16_f32 v119, v122, v123
    s_waitcnt lgkmcnt(4)
    v_mfma_f32_32x32x16_bf16 v[52:67], v[112:115], v[36:39], v[52:67]
    ds_read_b64_tr_b16 v[28:29], v21 offset:32768
    ds_read_b64_tr_b16 v[30:31], v21 offset:33280
    v_lshlrev_b32 v1, 16, v245
    v_and_b32 v4, s10, v245
    v_cvt_pk_bf16_f32 v120, v124, v125
    v_cvt_pk_bf16_f32 v121, v126, v127
    v_mfma_f32_32x32x16_bf16 v[68:83], v[112:115], v[40:43], v[68:83]
    ds_read_b64_tr_b16 v[32:33], v25 offset:32768
    ds_read_b64_tr_b16 v[34:35], v25 offset:33280
    v_fma_f32 v1, v1, v2, v3
    v_cvt_pk_bf16_f32 v122, v128, v129
    v_cvt_pk_bf16_f32 v123, v130, v131
    s_waitcnt lgkmcnt(4)
    v_mfma_f32_32x32x16_bf16 v[52:67], v[116:119], v[44:47], v[52:67]
    ds_read_b64_tr_b16 v[36:37], v22 offset:32768
    ds_read_b64_tr_b16 v[38:39], v22 offset:33280
    v_fma_f32 v4, v4, v2, v3
    v_cvt_pk_bf16_f32 v245, v1, v4
    v_cvt_pk_bf16_f32 v124, v132, v133
    v_cvt_pk_bf16_f32 v125, v134, v135
    v_mfma_f32_32x32x16_bf16 v[68:83], v[116:119], v[48:51], v[68:83]
    ds_read_b64_tr_b16 v[40:41], v26 offset:32768
    ds_read_b64_tr_b16 v[42:43], v26 offset:33280
    v_lshlrev_b32 v7, 16, v246
    v_cvt_pk_bf16_f32 v126, v136, v137
    v_cvt_pk_bf16_f32 v127, v138, v139
    s_waitcnt lgkmcnt(4)
    v_mfma_f32_32x32x16_bf16 v[52:67], v[120:123], v[28:31], v[52:67]
    ds_read_b64_tr_b16 v[44:45], v23 offset:32768
    ds_read_b64_tr_b16 v[46:47], v23 offset:33280
    v_and_b32 v19, s10, v246
    v_fma_f32 v7, v7, v2, v3
    v_cvt_pk_bf16_f32 v128, v140, v141
    v_cvt_pk_bf16_f32 v129, v142, v143
    v_mfma_f32_32x32x16_bf16 v[68:83], v[120:123], v[32:35], v[68:83]
    ds_read_b64_tr_b16 v[48:49], v27 offset:32768
    ds_read_b64_tr_b16 v[50:51], v27 offset:33280
    v_fma_f32 v19, v19, v2, v3
    v_cvt_pk_bf16_f32 v130, v144, v145
    v_cvt_pk_bf16_f32 v131, v146, v147
    s_waitcnt lgkmcnt(4)
    v_mfma_f32_32x32x16_bf16 v[52:67], v[124:127], v[36:39], v[52:67]
    s_barrier
    ds_read_b64_tr_b16 v[28:29], v20 offset:34816
    ds_read_b64_tr_b16 v[30:31], v20 offset:35328
    v_cvt_pk_bf16_f32 v246, v7, v19
    v_lshlrev_b32 v1, 16, v247
    v_cvt_pk_bf16_f32 v132, v148, v149
    v_cvt_pk_bf16_f32 v133, v150, v151
    v_mfma_f32_32x32x16_bf16 v[68:83], v[124:127], v[40:43], v[68:83]
    ds_read_b64_tr_b16 v[32:33], v24 offset:34816
    ds_read_b64_tr_b16 v[34:35], v24 offset:35328
    v_and_b32 v4, s10, v247
    v_cvt_pk_bf16_f32 v134, v152, v153
    v_cvt_pk_bf16_f32 v135, v154, v155
    s_waitcnt lgkmcnt(4)
    v_mfma_f32_32x32x16_bf16 v[52:67], v[128:131], v[44:47], v[52:67]
    ds_read_b64_tr_b16 v[36:37], v21 offset:34816
    ds_read_b64_tr_b16 v[38:39], v21 offset:35328
    v_fma_f32 v1, v1, v2, v3
    v_fma_f32 v4, v4, v2, v3
    v_cvt_pk_bf16_f32 v136, v156, v157
    v_cvt_pk_bf16_f32 v137, v158, v159
    v_mfma_f32_32x32x16_bf16 v[68:83], v[128:131], v[48:51], v[68:83]
    ds_read_b64_tr_b16 v[40:41], v25 offset:34816
    ds_read_b64_tr_b16 v[42:43], v25 offset:35328
    v_cvt_pk_bf16_f32 v247, v1, v4
    v_cvt_pk_bf16_f32 v138, v160, v161
    v_cvt_pk_bf16_f32 v139, v162, v163
    s_waitcnt lgkmcnt(4)
    v_mfma_f32_32x32x16_bf16 v[52:67], v[132:135], v[28:31], v[52:67]
    ds_read_b64_tr_b16 v[44:45], v22 offset:34816
    ds_read_b64_tr_b16 v[46:47], v22 offset:35328
    v_lshlrev_b32 v7, 16, v248
    v_and_b32 v19, s10, v248
    v_cvt_pk_bf16_f32 v140, v164, v165
    v_cvt_pk_bf16_f32 v141, v166, v167
    v_mfma_f32_32x32x16_bf16 v[68:83], v[132:135], v[32:35], v[68:83]
    ds_read_b64_tr_b16 v[48:49], v26 offset:34816
    ds_read_b64_tr_b16 v[50:51], v26 offset:35328
    v_fma_f32 v7, v7, v2, v3
    v_cvt_pk_bf16_f32 v142, v168, v169
    v_cvt_pk_bf16_f32 v143, v170, v171
    s_waitcnt lgkmcnt(4)
    v_mfma_f32_32x32x16_bf16 v[52:67], v[136:139], v[36:39], v[52:67]
    ds_read_b64_tr_b16 v[28:29], v23 offset:34816
    ds_read_b64_tr_b16 v[30:31], v23 offset:35328
    v_fma_f32 v19, v19, v2, v3
    v_cvt_pk_bf16_f32 v248, v7, v19
    v_cvt_pk_bf16_f32 v144, v172, v173
    v_cvt_pk_bf16_f32 v145, v174, v175
    v_mfma_f32_32x32x16_bf16 v[68:83], v[136:139], v[40:43], v[68:83]
    ds_read_b64_tr_b16 v[32:33], v27 offset:34816
    ds_read_b64_tr_b16 v[34:35], v27 offset:35328
    v_lshlrev_b32 v1, 16, v249
    v_cvt_pk_bf16_f32 v146, v176, v177
    v_cvt_pk_bf16_f32 v147, v178, v179
    s_waitcnt lgkmcnt(4)
    v_mfma_f32_32x32x16_bf16 v[52:67], v[140:143], v[44:47], v[52:67]
    s_barrier
    ds_read_b64_tr_b16 v[36:37], v20 offset:36864
    ds_read_b64_tr_b16 v[38:39], v20 offset:37376
    v_and_b32 v4, s10, v249
    v_fma_f32 v1, v1, v2, v3
    v_cvt_pk_bf16_f32 v148, v180, v181
    v_cvt_pk_bf16_f32 v149, v182, v183
    v_mfma_f32_32x32x16_bf16 v[68:83], v[140:143], v[48:51], v[68:83]
    ds_read_b64_tr_b16 v[40:41], v24 offset:36864
    ds_read_b64_tr_b16 v[42:43], v24 offset:37376
    v_fma_f32 v4, v4, v2, v3
    v_cvt_pk_bf16_f32 v150, v184, v185
    v_cvt_pk_bf16_f32 v151, v186, v187
    s_waitcnt lgkmcnt(4)
    v_mfma_f32_32x32x16_bf16 v[52:67], v[144:147], v[28:31], v[52:67]
    ds_read_b64_tr_b16 v[44:45], v21 offset:36864
    ds_read_b64_tr_b16 v[46:47], v21 offset:37376
    v_cvt_pk_bf16_f32 v249, v1, v4
    v_lshlrev_b32 v7, 16, v250
    v_cvt_pk_bf16_f32 v152, v188, v189
    v_cvt_pk_bf16_f32 v153, v190, v191
    v_mfma_f32_32x32x16_bf16 v[68:83], v[144:147], v[32:35], v[68:83]
    ds_read_b64_tr_b16 v[48:49], v25 offset:36864
    ds_read_b64_tr_b16 v[50:51], v25 offset:37376
    v_and_b32 v19, s10, v250
    v_cvt_pk_bf16_f32 v154, v192, v193
    v_cvt_pk_bf16_f32 v155, v194, v195
    s_waitcnt lgkmcnt(4)
    v_mfma_f32_32x32x16_bf16 v[52:67], v[148:151], v[36:39], v[52:67]
    ds_read_b64_tr_b16 v[28:29], v22 offset:36864
    ds_read_b64_tr_b16 v[30:31], v22 offset:37376
    v_fma_f32 v7, v7, v2, v3
    v_fma_f32 v19, v19, v2, v3
    v_cvt_pk_bf16_f32 v156, v196, v197
    v_cvt_pk_bf16_f32 v157, v198, v199
    v_mfma_f32_32x32x16_bf16 v[68:83], v[148:151], v[40:43], v[68:83]
    ds_read_b64_tr_b16 v[32:33], v26 offset:36864
    ds_read_b64_tr_b16 v[34:35], v26 offset:37376
    v_cvt_pk_bf16_f32 v250, v7, v19
    v_cvt_pk_bf16_f32 v158, v200, v201
    v_cvt_pk_bf16_f32 v159, v202, v203
    v_lshlrev_b32 v1, 16, v251
    s_waitcnt lgkmcnt(4)
    v_mfma_f32_32x32x16_bf16 v[52:67], v[152:155], v[44:47], v[52:67]
    ds_read_b64_tr_b16 v[36:37], v23 offset:36864
    ds_read_b64_tr_b16 v[38:39], v23 offset:37376
    v_and_b32 v4, s10, v251
    v_fma_f32 v1, v1, v2, v3
    v_cvt_pk_bf16_f32 v160, v204, v205
    v_cvt_pk_bf16_f32 v161, v206, v207
    v_fma_f32 v4, v4, v2, v3
    v_mfma_f32_32x32x16_bf16 v[68:83], v[152:155], v[48:51], v[68:83]
    ds_read_b64_tr_b16 v[40:41], v27 offset:36864
    ds_read_b64_tr_b16 v[42:43], v27 offset:37376
    v_cvt_pk_bf16_f32 v251, v1, v4
    v_cvt_pk_bf16_f32 v162, v208, v209
    v_cvt_pk_bf16_f32 v163, v210, v211
    v_lshlrev_b32 v7, 16, v252
    s_waitcnt lgkmcnt(4)
    v_mfma_f32_32x32x16_bf16 v[52:67], v[156:159], v[28:31], v[52:67]
    s_barrier
    ds_read_b64_tr_b16 v[44:45], v20 offset:38912
    ds_read_b64_tr_b16 v[46:47], v20 offset:39424
    v_and_b32 v19, s10, v252
    v_fma_f32 v7, v7, v2, v3
    v_cvt_pk_bf16_f32 v164, v212, v213
    v_cvt_pk_bf16_f32 v165, v214, v215
    v_fma_f32 v19, v19, v2, v3
    v_mfma_f32_32x32x16_bf16 v[68:83], v[156:159], v[32:35], v[68:83]
    ds_read_b64_tr_b16 v[48:49], v24 offset:38912
    ds_read_b64_tr_b16 v[50:51], v24 offset:39424
    v_cvt_pk_bf16_f32 v252, v7, v19
    v_cvt_pk_bf16_f32 v166, v216, v217
    v_cvt_pk_bf16_f32 v167, v218, v219
    v_lshlrev_b32 v1, 16, v253
    s_waitcnt lgkmcnt(4)
    v_mfma_f32_32x32x16_bf16 v[52:67], v[160:163], v[36:39], v[52:67]
    ds_read_b64_tr_b16 v[28:29], v21 offset:38912
    ds_read_b64_tr_b16 v[30:31], v21 offset:39424
    v_and_b32 v4, s10, v253
    v_fma_f32 v1, v1, v2, v3
    v_cvt_pk_bf16_f32 v168, v220, v221
    v_cvt_pk_bf16_f32 v169, v222, v223
    v_mfma_f32_32x32x16_bf16 v[68:83], v[160:163], v[40:43], v[68:83]
    ds_read_b64_tr_b16 v[32:33], v25 offset:38912
    ds_read_b64_tr_b16 v[34:35], v25 offset:39424
    v_fma_f32 v4, v4, v2, v3
    v_cvt_pk_bf16_f32 v170, v224, v225
    v_cvt_pk_bf16_f32 v171, v226, v227
    v_cvt_pk_bf16_f32 v253, v1, v4
    v_lshlrev_b32 v7, 16, v254
    s_waitcnt lgkmcnt(4)
    v_mfma_f32_32x32x16_bf16 v[52:67], v[164:167], v[44:47], v[52:67]
    ds_read_b64_tr_b16 v[36:37], v22 offset:38912
    ds_read_b64_tr_b16 v[38:39], v22 offset:39424
    v_and_b32 v19, s10, v254
    v_fma_f32 v7, v7, v2, v3
    v_cvt_pk_bf16_f32 v172, v228, v229
    v_cvt_pk_bf16_f32 v173, v230, v231
    v_mfma_f32_32x32x16_bf16 v[68:83], v[164:167], v[48:51], v[68:83]
    ds_read_b64_tr_b16 v[40:41], v26 offset:38912
    ds_read_b64_tr_b16 v[42:43], v26 offset:39424
    v_fma_f32 v19, v19, v2, v3
    v_cvt_pk_bf16_f32 v174, v232, v233
    v_cvt_pk_bf16_f32 v175, v234, v235
    v_cvt_pk_bf16_f32 v254, v7, v19
    v_lshlrev_b32 v1, 16, v255
    s_waitcnt lgkmcnt(4)
    v_mfma_f32_32x32x16_bf16 v[52:67], v[168:171], v[28:31], v[52:67]
    ds_read_b64_tr_b16 v[44:45], v23 offset:38912
    ds_read_b64_tr_b16 v[46:47], v23 offset:39424
    v_and_b32 v4, s10, v255
    v_fma_f32 v1, v1, v2, v3
    v_fma_f32 v4, v4, v2, v3
    v_cvt_pk_bf16_f32 v255, v1, v4
    v_mfma_f32_32x32x16_bf16 v[68:83], v[168:171], v[32:35], v[68:83]
    ds_read_b64_tr_b16 v[48:49], v27 offset:38912
    ds_read_b64_tr_b16 v[50:51], v27 offset:39424
    s_waitcnt lgkmcnt(4)
    v_mfma_f32_32x32x16_bf16 v[52:67], v[172:175], v[36:39], v[52:67]
    s_barrier
    ds_read_b64_tr_b16 v[28:29], v20 offset:0
    ds_read_b64_tr_b16 v[30:31], v20 offset:512
    v_mfma_f32_32x32x16_bf16 v[68:83], v[172:175], v[40:43], v[68:83]
    ds_read_b64_tr_b16 v[32:33], v24 offset:0
    ds_read_b64_tr_b16 v[34:35], v24 offset:512
    s_waitcnt lgkmcnt(4)
    v_mfma_f32_32x32x16_bf16 v[52:67], v[236:239], v[44:47], v[52:67]
    ds_read_b64_tr_b16 v[36:37], v21 offset:0
    ds_read_b64_tr_b16 v[38:39], v21 offset:512
    v_mfma_f32_32x32x16_bf16 v[68:83], v[236:239], v[48:51], v[68:83]
    ds_read_b64_tr_b16 v[40:41], v25 offset:0
    ds_read_b64_tr_b16 v[42:43], v25 offset:512
    s_waitcnt lgkmcnt(4)
    v_mfma_f32_32x32x16_bf16 v[52:67], v[240:243], v[28:31], v[52:67]
    ds_read_b64_tr_b16 v[44:45], v22 offset:0
    ds_read_b64_tr_b16 v[46:47], v22 offset:512
    v_mfma_f32_32x32x16_bf16 v[68:83], v[240:243], v[32:35], v[68:83]
    ds_read_b64_tr_b16 v[48:49], v26 offset:0
    ds_read_b64_tr_b16 v[50:51], v26 offset:512
    s_waitcnt lgkmcnt(4)
    v_mfma_f32_32x32x16_bf16 v[52:67], v[244:247], v[36:39], v[52:67]
    ds_read_b64_tr_b16 v[28:29], v23 offset:0
    ds_read_b64_tr_b16 v[30:31], v23 offset:512
    v_mfma_f32_32x32x16_bf16 v[68:83], v[244:247], v[40:43], v[68:83]
    ds_read_b64_tr_b16 v[32:33], v27 offset:0
    ds_read_b64_tr_b16 v[34:35], v27 offset:512
    s_waitcnt lgkmcnt(4)
    v_mfma_f32_32x32x16_bf16 v[52:67], v[248:251], v[44:47], v[52:67]
    s_barrier
    ds_read_b64_tr_b16 v[36:37], v20 offset:2048
    ds_read_b64_tr_b16 v[38:39], v20 offset:2560
    v_mfma_f32_32x32x16_bf16 v[68:83], v[248:251], v[48:51], v[68:83]
    ds_read_b64_tr_b16 v[40:41], v24 offset:2048
    ds_read_b64_tr_b16 v[42:43], v24 offset:2560
    s_waitcnt lgkmcnt(4)
    v_mfma_f32_32x32x16_bf16 v[52:67], v[252:255], v[28:31], v[52:67]
    ds_read_b64_tr_b16 v[44:45], v21 offset:2048
    ds_read_b64_tr_b16 v[46:47], v21 offset:2560
    v_mfma_f32_32x32x16_bf16 v[68:83], v[252:255], v[32:35], v[68:83]
    ds_read_b64_tr_b16 v[48:49], v25 offset:2048
    ds_read_b64_tr_b16 v[50:51], v25 offset:2560
    s_waitcnt lgkmcnt(4)
    v_mfma_f32_32x32x16_bf16 v[176:191], v[84:87], v[36:39], 0
    ds_read_b64_tr_b16 v[28:29], v22 offset:2048
    ds_read_b64_tr_b16 v[30:31], v22 offset:2560
    v_and_b32 v19, 15, v0
    v_lshlrev_b32 v19, 2, v19
    global_load_dword v19, v19, s[22:23] sc1
    v_mfma_f32_32x32x16_bf16 v[192:207], v[84:87], v[40:43], 0
    ds_read_b64_tr_b16 v[32:33], v26 offset:2048
    ds_read_b64_tr_b16 v[34:35], v26 offset:2560
    s_waitcnt lgkmcnt(4)
    v_mfma_f32_32x32x16_bf16 v[176:191], v[88:91], v[44:47], v[176:191]
    ds_read_b64_tr_b16 v[36:37], v23 offset:2048
    ds_read_b64_tr_b16 v[38:39], v23 offset:2560
    v_mov_b32 v1, 0x3f803f80
    v_mul_f32 v232, s50, v52
    v_exp_f32_e64 v232, v232 clamp
    v_max_f32 v52, s51, v52
    v_add_f32 v232, v232, v52
    v_mfma_f32_32x32x16_bf16 v[192:207], v[88:91], v[48:51], v[192:207]
    ds_read_b64_tr_b16 v[40:41], v27 offset:2048
    ds_read_b64_tr_b16 v[42:43], v27 offset:2560
    v_mul_f32 v233, s50, v53
    v_exp_f32_e64 v233, v233 clamp
    v_max_f32 v53, s51, v53
    v_add_f32 v233, v233, v53
    s_waitcnt lgkmcnt(4)
    v_mfma_f32_32x32x16_bf16 v[176:191], v[92:95], v[28:31], v[176:191]
    s_barrier
    ds_read_b64_tr_b16 v[44:45], v20 offset:4096
    ds_read_b64_tr_b16 v[46:47], v20 offset:4608
    v_cvt_pk_bf16_f32 v208, v232, v233
    v_mul_f32 v234, s50, v54
    v_exp_f32_e64 v234, v234 clamp
    v_max_f32 v54, s51, v54
    v_add_f32 v234, v234, v54
    v_mfma_f32_32x32x16_bf16 v[192:207], v[92:95], v[32:35], v[192:207]
    ds_read_b64_tr_b16 v[48:49], v24 offset:4096
    ds_read_b64_tr_b16 v[50:51], v24 offset:4608
    v_mul_f32 v235, s50, v55
    v_exp_f32_e64 v235, v235 clamp
    v_max_f32 v55, s51, v55
    v_add_f32 v235, v235, v55
    s_waitcnt lgkmcnt(4)
    v_mfma_f32_32x32x16_bf16 v[176:191], v[96:99], v[36:39], v[176:191]
    ds_read_b64_tr_b16 v[28:29], v21 offset:4096
    ds_read_b64_tr_b16 v[30:31], v21 offset:4608
    v_cvt_pk_bf16_f32 v209, v234, v235
    v_mul_f32 v232, s50, v56
    v_exp_f32_e64 v232, v232 clamp
    v_max_f32 v56, s51, v56
    v_add_f32 v232, v232, v56
    v_mfma_f32_32x32x16_bf16 v[192:207], v[96:99], v[40:43], v[192:207]
    ds_read_b64_tr_b16 v[32:33], v25 offset:4096
    ds_read_b64_tr_b16 v[34:35], v25 offset:4608
    v_mul_f32 v233, s50, v57
    v_exp_f32_e64 v233, v233 clamp
    v_max_f32 v57, s51, v57
    v_add_f32 v233, v233, v57
    s_waitcnt lgkmcnt(4)
    v_mfma_f32_32x32x16_bf16 v[176:191], v[100:103], v[44:47], v[176:191]
    ds_read_b64_tr_b16 v[36:37], v22 offset:4096
    ds_read_b64_tr_b16 v[38:39], v22 offset:4608
    v_cvt_pk_bf16_f32 v210, v232, v233
    v_mul_f32 v234, s50, v58
    v_exp_f32_e64 v234, v234 clamp
    v_max_f32 v58, s51, v58
    v_add_f32 v234, v234, v58
    v_mfma_f32_32x32x16_bf16 v[192:207], v[100:103], v[48:51], v[192:207]
    ds_read_b64_tr_b16 v[40:41], v26 offset:4096
    ds_read_b64_tr_b16 v[42:43], v26 offset:4608
    v_mul_f32 v235, s50, v59
    v_exp_f32_e64 v235, v235 clamp
    v_max_f32 v59, s51, v59
    v_add_f32 v235, v235, v59
    s_waitcnt lgkmcnt(4)
    v_mfma_f32_32x32x16_bf16 v[176:191], v[104:107], v[28:31], v[176:191]
    ds_read_b64_tr_b16 v[44:45], v23 offset:4096
    ds_read_b64_tr_b16 v[46:47], v23 offset:4608
    v_cvt_pk_bf16_f32 v211, v234, v235
    v_mul_f32 v232, s50, v60
    v_exp_f32_e64 v232, v232 clamp
    v_max_f32 v60, s51, v60
    v_add_f32 v232, v232, v60
    v_mfma_f32_32x32x16_bf16 v[192:207], v[104:107], v[32:35], v[192:207]
    ds_read_b64_tr_b16 v[48:49], v27 offset:4096
    ds_read_b64_tr_b16 v[50:51], v27 offset:4608
    v_mul_f32 v233, s50, v61
    v_exp_f32_e64 v233, v233 clamp
    v_max_f32 v61, s51, v61
    v_add_f32 v233, v233, v61
    s_waitcnt lgkmcnt(4)
    v_mfma_f32_32x32x16_bf16 v[176:191], v[108:111], v[36:39], v[176:191]
    s_barrier
    ds_read_b64_tr_b16 v[28:29], v20 offset:6144
    ds_read_b64_tr_b16 v[30:31], v20 offset:6656
    v_cvt_pk_bf16_f32 v212, v232, v233
    v_mul_f32 v234, s50, v62
    v_exp_f32_e64 v234, v234 clamp
    v_max_f32 v62, s51, v62
    v_add_f32 v234, v234, v62
    v_mfma_f32_32x32x16_bf16 v[192:207], v[108:111], v[40:43], v[192:207]
    ds_read_b64_tr_b16 v[32:33], v24 offset:6144
    ds_read_b64_tr_b16 v[34:35], v24 offset:6656
    v_mul_f32 v235, s50, v63
    v_exp_f32_e64 v235, v235 clamp
    v_max_f32 v63, s51, v63
    v_add_f32 v235, v235, v63
    s_waitcnt lgkmcnt(4)
    v_mfma_f32_32x32x16_bf16 v[176:191], v[112:115], v[44:47], v[176:191]
    ds_read_b64_tr_b16 v[36:37], v21 offset:6144
    ds_read_b64_tr_b16 v[38:39], v21 offset:6656
    v_cvt_pk_bf16_f32 v213, v234, v235
    v_mul_f32 v232, s50, v64
    v_exp_f32_e64 v232, v232 clamp
    v_max_f32 v64, s51, v64
    v_add_f32 v232, v232, v64
    v_mfma_f32_32x32x16_bf16 v[192:207], v[112:115], v[48:51], v[192:207]
    ds_read_b64_tr_b16 v[40:41], v25 offset:6144
    ds_read_b64_tr_b16 v[42:43], v25 offset:6656
    v_mul_f32 v233, s50, v65
    v_exp_f32_e64 v233, v233 clamp
    v_max_f32 v65, s51, v65
    v_add_f32 v233, v233, v65
    s_waitcnt lgkmcnt(4)
    v_mfma_f32_32x32x16_bf16 v[176:191], v[116:119], v[28:31], v[176:191]
    ds_read_b64_tr_b16 v[44:45], v22 offset:6144
    ds_read_b64_tr_b16 v[46:47], v22 offset:6656
    v_cvt_pk_bf16_f32 v214, v232, v233
    v_mul_f32 v234, s50, v66
    v_exp_f32_e64 v234, v234 clamp
    v_max_f32 v66, s51, v66
    v_add_f32 v234, v234, v66
    v_mfma_f32_32x32x16_bf16 v[192:207], v[116:119], v[32:35], v[192:207]
    ds_read_b64_tr_b16 v[48:49], v26 offset:6144
    ds_read_b64_tr_b16 v[50:51], v26 offset:6656
    v_mul_f32 v235, s50, v67
    v_exp_f32_e64 v235, v235 clamp
    v_max_f32 v67, s51, v67
    v_add_f32 v235, v235, v67
    s_waitcnt lgkmcnt(4)
    v_mfma_f32_32x32x16_bf16 v[176:191], v[120:123], v[36:39], v[176:191]
    ds_read_b64_tr_b16 v[28:29], v23 offset:6144
    ds_read_b64_tr_b16 v[30:31], v23 offset:6656
    v_cvt_pk_bf16_f32 v215, v234, v235
    v_mul_f32 v232, s50, v68
    v_exp_f32_e64 v232, v232 clamp
    v_max_f32 v68, s51, v68
    v_add_f32 v232, v232, v68
    v_mfma_f32_32x32x16_bf16 v[192:207], v[120:123], v[40:43], v[192:207]
    ds_read_b64_tr_b16 v[32:33], v27 offset:6144
    ds_read_b64_tr_b16 v[34:35], v27 offset:6656
    v_mul_f32 v233, s50, v69
    v_exp_f32_e64 v233, v233 clamp
    v_max_f32 v69, s51, v69
    v_add_f32 v233, v233, v69
    s_waitcnt lgkmcnt(4)
    v_mfma_f32_32x32x16_bf16 v[176:191], v[124:127], v[44:47], v[176:191]
    s_barrier
    ds_read_b64_tr_b16 v[36:37], v20 offset:8192
    ds_read_b64_tr_b16 v[38:39], v20 offset:8704
    v_cvt_pk_bf16_f32 v224, v232, v233
    v_mul_f32 v234, s50, v70
    v_exp_f32_e64 v234, v234 clamp
    v_max_f32 v70, s51, v70
    v_add_f32 v234, v234, v70
    v_mfma_f32_32x32x16_bf16 v[192:207], v[124:127], v[48:51], v[192:207]
    ds_read_b64_tr_b16 v[40:41], v24 offset:8192
    ds_read_b64_tr_b16 v[42:43], v24 offset:8704
    v_mul_f32 v235, s50, v71
    v_exp_f32_e64 v235, v235 clamp
    v_max_f32 v71, s51, v71
    v_add_f32 v235, v235, v71
    s_waitcnt lgkmcnt(4)
    v_mfma_f32_32x32x16_bf16 v[176:191], v[128:131], v[28:31], v[176:191]
    ds_read_b64_tr_b16 v[44:45], v21 offset:8192
    ds_read_b64_tr_b16 v[46:47], v21 offset:8704
    v_cvt_pk_bf16_f32 v225, v234, v235
    v_mul_f32 v232, s50, v72
    v_exp_f32_e64 v232, v232 clamp
    v_max_f32 v72, s51, v72
    v_add_f32 v232, v232, v72
    v_mfma_f32_32x32x16_bf16 v[192:207], v[128:131], v[32:35], v[192:207]
    ds_read_b64_tr_b16 v[48:49], v25 offset:8192
    ds_read_b64_tr_b16 v[50:51], v25 offset:8704
    v_mul_f32 v233, s50, v73
    v_exp_f32_e64 v233, v233 clamp
    v_max_f32 v73, s51, v73
    v_add_f32 v233, v233, v73
    s_waitcnt lgkmcnt(4)
    v_mfma_f32_32x32x16_bf16 v[176:191], v[132:135], v[36:39], v[176:191]
    ds_read_b64_tr_b16 v[28:29], v22 offset:8192
    ds_read_b64_tr_b16 v[30:31], v22 offset:8704
    v_cvt_pk_bf16_f32 v226, v232, v233
    v_mul_f32 v234, s50, v74
    v_exp_f32_e64 v234, v234 clamp
    v_max_f32 v74, s51, v74
    v_add_f32 v234, v234, v74
    v_mfma_f32_32x32x16_bf16 v[192:207], v[132:135], v[40:43], v[192:207]
    ds_read_b64_tr_b16 v[32:33], v26 offset:8192
    ds_read_b64_tr_b16 v[34:35], v26 offset:8704
    v_mul_f32 v235, s50, v75
    v_exp_f32_e64 v235, v235 clamp
    v_max_f32 v75, s51, v75
    v_add_f32 v235, v235, v75
    s_waitcnt lgkmcnt(4)
    v_mfma_f32_32x32x16_bf16 v[176:191], v[136:139], v[44:47], v[176:191]
    ds_read_b64_tr_b16 v[36:37], v23 offset:8192
    ds_read_b64_tr_b16 v[38:39], v23 offset:8704
    v_cvt_pk_bf16_f32 v227, v234, v235
    v_mul_f32 v232, s50, v76
    v_exp_f32_e64 v232, v232 clamp
    v_max_f32 v76, s51, v76
    v_add_f32 v232, v232, v76
    v_mfma_f32_32x32x16_bf16 v[192:207], v[136:139], v[48:51], v[192:207]
    ds_read_b64_tr_b16 v[40:41], v27 offset:8192
    ds_read_b64_tr_b16 v[42:43], v27 offset:8704
    v_mul_f32 v233, s50, v77
    v_exp_f32_e64 v233, v233 clamp
    v_max_f32 v77, s51, v77
    v_add_f32 v233, v233, v77
    s_waitcnt lgkmcnt(4)
    v_mfma_f32_32x32x16_bf16 v[176:191], v[140:143], v[28:31], v[176:191]
    s_barrier
    ds_read_b64_tr_b16 v[44:45], v20 offset:10240
    ds_read_b64_tr_b16 v[46:47], v20 offset:10752
    v_cvt_pk_bf16_f32 v228, v232, v233
    v_mul_f32 v234, s50, v78
    v_exp_f32_e64 v234, v234 clamp
    v_max_f32 v78, s51, v78
    v_add_f32 v234, v234, v78
    v_mfma_f32_32x32x16_bf16 v[192:207], v[140:143], v[32:35], v[192:207]
    ds_read_b64_tr_b16 v[48:49], v24 offset:10240
    ds_read_b64_tr_b16 v[50:51], v24 offset:10752
    v_mul_f32 v235, s50, v79
    v_exp_f32_e64 v235, v235 clamp
    v_max_f32 v79, s51, v79
    v_add_f32 v235, v235, v79
    s_waitcnt lgkmcnt(4)
    v_mfma_f32_32x32x16_bf16 v[176:191], v[144:147], v[36:39], v[176:191]
    ds_read_b64_tr_b16 v[28:29], v21 offset:10240
    ds_read_b64_tr_b16 v[30:31], v21 offset:10752
    v_cvt_pk_bf16_f32 v229, v234, v235
    v_mul_f32 v232, s50, v80
    v_exp_f32_e64 v232, v232 clamp
    v_max_f32 v80, s51, v80
    v_add_f32 v232, v232, v80
    v_mfma_f32_32x32x16_bf16 v[192:207], v[144:147], v[40:43], v[192:207]
    ds_read_b64_tr_b16 v[32:33], v25 offset:10240
    ds_read_b64_tr_b16 v[34:35], v25 offset:10752
    v_mul_f32 v233, s50, v81
    v_exp_f32_e64 v233, v233 clamp
    v_max_f32 v81, s51, v81
    v_add_f32 v233, v233, v81
    s_waitcnt lgkmcnt(4)
    v_mfma_f32_32x32x16_bf16 v[176:191], v[148:151], v[44:47], v[176:191]
    ds_read_b64_tr_b16 v[36:37], v22 offset:10240
    ds_read_b64_tr_b16 v[38:39], v22 offset:10752
    v_cvt_pk_bf16_f32 v230, v232, v233
    v_mul_f32 v234, s50, v82
    v_exp_f32_e64 v234, v234 clamp
    v_max_f32 v82, s51, v82
    v_add_f32 v234, v234, v82
    v_mfma_f32_32x32x16_bf16 v[192:207], v[148:151], v[48:51], v[192:207]
    ds_read_b64_tr_b16 v[40:41], v26 offset:10240
    ds_read_b64_tr_b16 v[42:43], v26 offset:10752
    v_mul_f32 v235, s50, v83
    v_exp_f32_e64 v235, v235 clamp
    v_max_f32 v83, s51, v83
    v_add_f32 v235, v235, v83
    s_waitcnt lgkmcnt(4)
    v_mfma_f32_32x32x16_bf16 v[176:191], v[152:155], v[28:31], v[176:191]
    ds_read_b64_tr_b16 v[44:45], v23 offset:10240
    ds_read_b64_tr_b16 v[46:47], v23 offset:10752
    v_cvt_pk_bf16_f32 v231, v234, v235
    s_waitcnt vmcnt(0)
    v_cmp_eq_u32 vcc, 0, v19
    s_cbranch_vccnz L_gol_18
L_go_17:
    v_mfma_f32_32x32x16_bf16 v[192:207], v[152:155], v[32:35], v[192:207]
    ds_read_b64_tr_b16 v[48:49], v27 offset:10240
    ds_read_b64_tr_b16 v[50:51], v27 offset:10752
    s_waitcnt lgkmcnt(4)
    v_mfma_f32_32x32x16_bf16 v[176:191], v[156:159], v[36:39], v[176:191]
    s_barrier
    ds_read_b64_tr_b16 v[28:29], v20 offset:12288
    ds_read_b64_tr_b16 v[30:31], v20 offset:12800
    v_mfma_f32_32x32x16_bf16 v[192:207], v[156:159], v[40:43], v[192:207]
    ds_read_b64_tr_b16 v[32:33], v24 offset:12288
    ds_read_b64_tr_b16 v[34:35], v24 offset:12800
    s_waitcnt lgkmcnt(4)
    v_mfma_f32_32x32x16_bf16 v[176:191], v[160:163], v[44:47], v[176:191]
    ds_read_b64_tr_b16 v[36:37], v21 offset:12288
    ds_read_b64_tr_b16 v[38:39], v21 offset:12800
    v_mfma_f32_32x32x16_bf16 v[192:207], v[160:163], v[48:51], v[192:207]
    ds_read_b64_tr_b16 v[40:41], v25 offset:12288
    ds_read_b64_tr_b16 v[42:43], v25 offset:12800
    s_waitcnt lgkmcnt(4)
    v_mfma_f32_32x32x16_bf16 v[176:191], v[164:167], v[28:31], v[176:191]
    ds_read_b64_tr_b16 v[44:45], v22 offset:12288
    ds_read_b64_tr_b16 v[46:47], v22 offset:12800
    v_mfma_f32_32x32x16_bf16 v[192:207], v[164:167], v[32:35], v[192:207]
    ds_read_b64_tr_b16 v[48:49], v26 offset:12288
    ds_read_b64_tr_b16 v[50:51], v26 offset:12800
    s_waitcnt lgkmcnt(4)
    v_mfma_f32_32x32x16_bf16 v[176:191], v[168:171], v[36:39], v[176:191]
    ds_read_b64_tr_b16 v[28:29], v23 offset:12288
    ds_read_b64_tr_b16 v[30:31], v23 offset:12800
    v_mfma_f32_32x32x16_bf16 v[192:207], v[168:171], v[40:43], v[192:207]
    ds_read_b64_tr_b16 v[32:33], v27 offset:12288
    ds_read_b64_tr_b16 v[34:35], v27 offset:12800
    s_waitcnt lgkmcnt(4)
    v_mfma_f32_32x32x16_bf16 v[176:191], v[172:175], v[44:47], v[176:191]
    s_barrier
    ds_read_b64_tr_b16 v[36:37], v20 offset:14336
    ds_read_b64_tr_b16 v[38:39], v20 offset:14848
    v_mfma_f32_32x32x16_bf16 v[192:207], v[172:175], v[48:51], v[192:207]
    ds_read_b64_tr_b16 v[40:41], v24 offset:14336
    ds_read_b64_tr_b16 v[42:43], v24 offset:14848
    s_waitcnt lgkmcnt(4)
    v_mfma_f32_32x32x16_bf16 v[176:191], v[236:239], v[28:31], v[176:191]
    ds_read_b64_tr_b16 v[44:45], v21 offset:14336
    ds_read_b64_tr_b16 v[46:47], v21 offset:14848
    v_mfma_f32_32x32x16_bf16 v[192:207], v[236:239], v[32:35], v[192:207]
    ds_read_b64_tr_b16 v[48:49], v25 offset:14336
    ds_read_b64_tr_b16 v[50:51], v25 offset:14848
    s_waitcnt lgkmcnt(4)
    v_mfma_f32_32x32x16_bf16 v[176:191], v[240:243], v[36:39], v[176:191]
    ds_read_b64_tr_b16 v[28:29], v22 offset:14336
    ds_read_b64_tr_b16 v[30:31], v22 offset:14848
    v_mfma_f32_32x32x16_bf16 v[192:207], v[240:243], v[40:43], v[192:207]
    ds_read_b64_tr_b16 v[32:33], v26 offset:14336
    ds_read_b64_tr_b16 v[34:35], v26 offset:14848
    s_waitcnt lgkmcnt(4)
    v_mfma_f32_32x32x16_bf16 v[176:191], v[244:247], v[44:47], v[176:191]
    ds_read_b64_tr_b16 v[36:37], v23 offset:14336
    ds_read_b64_tr_b16 v[38:39], v23 offset:14848
    v_mfma_f32_32x32x16_bf16 v[192:207], v[244:247], v[48:51], v[192:207]
    ds_read_b64_tr_b16 v[40:41], v27 offset:14336
    ds_read_b64_tr_b16 v[42:43], v27 offset:14848
    s_waitcnt lgkmcnt(4)
    v_mfma_f32_32x32x16_bf16 v[176:191], v[248:251], v[28:31], v[176:191]
    s_barrier
    ds_read_b64_tr_b16 v[44:45], v20 offset:16384
    ds_read_b64_tr_b16 v[46:47], v20 offset:16896
    v_mfma_f32_32x32x16_bf16 v[192:207], v[248:251], v[32:35], v[192:207]
    ds_read_b64_tr_b16 v[48:49], v21 offset:16384
    ds_read_b64_tr_b16 v[50:51], v21 offset:16896
    s_waitcnt lgkmcnt(4)
    v_mfma_f32_32x32x16_bf16 v[176:191], v[252:255], v[36:39], v[176:191]
    ds_read_b64_tr_b16 v[28:29], v22 offset:16384
    ds_read_b64_tr_b16 v[30:31], v22 offset:16896
    v_mfma_f32_32x32x16_bf16 v[192:207], v[252:255], v[40:43], v[192:207]
    ds_read_b64_tr_b16 v[32:33], v23 offset:16384
    ds_read_b64_tr_b16 v[34:35], v23 offset:16896
    s_waitcnt lgkmcnt(4)
    v_mfma_f32_32x32x16_bf16 v[52:67], v[44:47], v[84:87], 0
    ds_read_b64_tr_b16 v[36:37], v20 offset:18432
    ds_read_b64_tr_b16 v[38:39], v20 offset:18944
    v_mfma_f32_32x32x16_bf16 v[52:67], v[48:51], v[88:91], v[52:67]
    ds_read_b64_tr_b16 v[40:41], v21 offset:18432
    ds_read_b64_tr_b16 v[42:43], v21 offset:18944
    s_waitcnt lgkmcnt(4)
    v_mfma_f32_32x32x16_bf16 v[52:67], v[28:31], v[92:95], v[52:67]
    ds_read_b64_tr_b16 v[44:45], v22 offset:18432
    ds_read_b64_tr_b16 v[46:47], v22 offset:18944
    v_cvt_pk_bf16_f32 v216, v176, v177
    v_cndmask_b32 v216, v216, v1, s[48:49]
    v_cvt_pk_bf16_f32 v217, v178, v179
    v_cndmask_b32 v217, v217, v1, s[48:49]
    v_cvt_pk_bf16_f32 v218, v180, v181
    v_cndmask_b32 v218, v218, v1, s[48:49]
    v_cvt_pk_bf16_f32 v219, v182, v183
    v_cndmask_b32 v219, v219, v1, s[48:49]
    v_cvt_pk_bf16_f32 v220, v184, v185
    v_cndmask_b32 v220, v220, v1, s[48:49]
    v_cvt_pk_bf16_f32 v221, v186, v187
    v_cndmask_b32 v221, v221, v1, s[48:49]
    v_cvt_pk_bf16_f32 v222, v188, v189
    v_cndmask_b32 v222, v222, v1, s[48:49]
    v_cvt_pk_bf16_f32 v223, v190, v191
    v_cndmask_b32 v223, v223, v1, s[48:49]
    v_cvt_pk_bf16_f32 v192, v192, v193
    v_cndmask_b32 v192, v192, v1, s[62:63]
    v_mfma_f32_32x32x16_bf16 v[176:191], v[208:211], v[216:219], 0
    v_cvt_pk_bf16_f32 v193, v194, v195
    v_cndmask_b32 v193, v193, v1, s[62:63]
    v_mfma_f32_32x32x16_bf16 v[176:191], v[212:215], v[220:223], v[176:191]
    v_cvt_pk_bf16_f32 v194, v196, v197
    v_cndmask_b32 v194, v194, v1, s[62:63]
    v_cvt_pk_bf16_f32 v195, v198, v199
    v_cndmask_b32 v195, v195, v1, s[62:63]
    v_cvt_pk_bf16_f32 v196, v200, v201
    v_cndmask_b32 v196, v196, v1, s[62:63]
    v_cvt_pk_bf16_f32 v197, v202, v203
    v_cndmask_b32 v197, v197, v1, s[62:63]
    v_cvt_pk_bf16_f32 v198, v204, v205
    v_cndmask_b32 v198, v198, v1, s[62:63]
    v_cvt_pk_bf16_f32 v199, v206, v207
    v_cndmask_b32 v199, v199, v1, s[62:63]
    v_mfma_f32_32x32x16_bf16 v[208:223], v[224:227], v[192:195], 0
    s_nop 0
    v_mfma_f32_32x32x16_bf16 v[208:223], v[228:231], v[196:199], v[208:223]
    ds_write_b128 v10, v[176:179] offset:28672
    ds_write_b128 v10, v[180:183] offset:29696
    ds_write_b128 v10, v[184:187] offset:30720
    ds_write_b128 v10, v[188:191] offset:31744
    s_nop 7
    ds_write_b128 v10, v[208:211] offset:32768
    ds_write_b128 v10, v[212:215] offset:33792
    ds_write_b128 v10, v[216:219] offset:34816
    ds_write_b128 v10, v[220:223] offset:35840
    v_mfma_f32_32x32x16_bf16 v[52:67], v[32:35], v[96:99], v[52:67]
    ds_read_b64_tr_b16 v[48:49], v23 offset:18432
    ds_read_b64_tr_b16 v[50:51], v23 offset:18944
    s_waitcnt lgkmcnt(12)
    v_mfma_f32_32x32x16_bf16 v[52:67], v[36:39], v[100:103], v[52:67]
    s_barrier
    ds_read_b64_tr_b16 v[28:29], v20 offset:20480
    ds_read_b64_tr_b16 v[30:31], v20 offset:20992
    s_waitcnt lgkmcnt(4)
    s_barrier
    v_mfma_f32_32x32x16_bf16 v[52:67], v[40:43], v[104:107], v[52:67]
    ds_read_b64_tr_b16 v[32:33], v21 offset:20480
    ds_read_b64_tr_b16 v[34:35], v21 offset:20992
    s_waitcnt lgkmcnt(4)
    v_mfma_f32_32x32x16_bf16 v[52:67], v[44:47], v[108:111], v[52:67]
    ds_read_b64_tr_b16 v[36:37], v22 offset:20480
    ds_read_b64_tr_b16 v[38:39], v22 offset:20992
    v_mfma_f32_32x32x16_bf16 v[52:67], v[48:51], v[112:115], v[52:67]
    ds_read_b64_tr_b16 v[40:41], v23 offset:20480
    ds_read_b64_tr_b16 v[42:43], v23 offset:20992
    s_waitcnt lgkmcnt(4)
    v_mfma_f32_32x32x16_bf16 v[52:67], v[28:31], v[116:119], v[52:67]
    ds_read_b64_tr_b16 v[44:45], v20 offset:22528
    ds_read_b64_tr_b16 v[46:47], v20 offset:23040
    v_mfma_f32_32x32x16_bf16 v[52:67], v[32:35], v[120:123], v[52:67]
    ds_read_b64_tr_b16 v[48:49], v21 offset:22528
    ds_read_b64_tr_b16 v[50:51], v21 offset:23040
    s_waitcnt lgkmcnt(4)
    v_mfma_f32_32x32x16_bf16 v[52:67], v[36:39], v[124:127], v[52:67]
    ds_read_b64_tr_b16 v[28:29], v22 offset:22528
    ds_read_b64_tr_b16 v[30:31], v22 offset:23040
    v_mfma_f32_32x32x16_bf16 v[52:67], v[40:43], v[128:131], v[52:67]
    ds_read_b64_tr_b16 v[32:33], v23 offset:22528
    ds_read_b64_tr_b16 v[34:35], v23 offset:23040
    s_waitcnt lgkmcnt(4)
    v_mfma_f32_32x32x16_bf16 v[52:67], v[44:47], v[132:135], v[52:67]
    ds_read_b64_tr_b16 v[36:37], v20 offset:24576
    ds_read_b64_tr_b16 v[38:39], v20 offset:25088
    v_mfma_f32_32x32x16_bf16 v[52:67], v[48:51], v[136:139], v[52:67]
    ds_read_b64_tr_b16 v[40:41], v21 offset:24576
    ds_read_b64_tr_b16 v[42:43], v21 offset:25088
    s_waitcnt lgkmcnt(4)
    v_mfma_f32_32x32x16_bf16 v[52:67], v[28:31], v[140:143], v[52:67]
    ds_read_b64_tr_b16 v[44:45], v22 offset:24576
    ds_read_b64_tr_b16 v[46:47], v22 offset:25088
    v_mfma_f32_32x32x16_bf16 v[52:67], v[32:35], v[144:147], v[52:67]
    ds_read_b64_tr_b16 v[48:49], v23 offset:24576
    ds_read_b64_tr_b16 v[50:51], v23 offset:25088
    s_waitcnt lgkmcnt(4)
    v_mfma_f32_32x32x16_bf16 v[52:67], v[36:39], v[148:151], v[52:67]
    ds_read_b64_tr_b16 v[28:29], v20 offset:26624
    ds_read_b64_tr_b16 v[30:31], v20 offset:27136
    v_mfma_f32_32x32x16_bf16 v[52:67], v[40:43], v[152:155], v[52:67]
    ds_read_b64_tr_b16 v[32:33], v21 offset:26624
    ds_read_b64_tr_b16 v[34:35], v21 offset:27136
    s_waitcnt lgkmcnt(4)
    v_mfma_f32_32x32x16_bf16 v[52:67], v[44:47], v[156:159], v[52:67]
    ds_read_b64_tr_b16 v[36:37], v22 offset:26624
    ds_read_b64_tr_b16 v[38:39], v22 offset:27136
    v_mfma_f32_32x32x16_bf16 v[52:67], v[48:51], v[160:163], v[52:67]
    ds_read_b64_tr_b16 v[40:41], v23 offset:26624
    ds_read_b64_tr_b16 v[42:43], v23 offset:27136
    s_waitcnt lgkmcnt(4)
    v_mfma_f32_32x32x16_bf16 v[52:67], v[28:31], v[164:167], v[52:67]
    ds_read_b64_tr_b16 v[44:45], v20 offset:36864
    ds_read_b64_tr_b16 v[46:47], v20 offset:37376
    v_mfma_f32_32x32x16_bf16 v[52:67], v[32:35], v[168:171], v[52:67]
    ds_read_b64_tr_b16 v[48:49], v21 offset:36864
    ds_read_b64_tr_b16 v[50:51], v21 offset:37376
    s_waitcnt lgkmcnt(4)
    v_mfma_f32_32x32x16_bf16 v[52:67], v[36:39], v[172:175], v[52:67]
    ds_read_b64_tr_b16 v[28:29], v22 offset:36864
    ds_read_b64_tr_b16 v[30:31], v22 offset:37376
    v_mfma_f32_32x32x16_bf16 v[52:67], v[40:43], v[236:239], v[52:67]
    ds_read_b64_tr_b16 v[32:33], v23 offset:36864
    ds_read_b64_tr_b16 v[34:35], v23 offset:37376
    s_waitcnt lgkmcnt(4)
    v_mfma_f32_32x32x16_bf16 v[52:67], v[44:47], v[240:243], v[52:67]
    ds_read_b64_tr_b16 v[36:37], v14 offset:16384
    ds_read_b64_tr_b16 v[38:39], v14 offset:16896
    v_mfma_f32_32x32x16_bf16 v[52:67], v[48:51], v[244:247], v[52:67]
    ds_read_b64_tr_b16 v[40:41], v15 offset:16384
    ds_read_b64_tr_b16 v[42:43], v15 offset:16896
    s_waitcnt lgkmcnt(4)
    v_mfma_f32_32x32x16_bf16 v[52:67], v[28:31], v[248:251], v[52:67]
    ds_read_b64_tr_b16 v[44:45], v16 offset:16384
    ds_read_b64_tr_b16 v[46:47], v16 offset:16896
    v_mfma_f32_32x32x16_bf16 v[52:67], v[32:35], v[252:255], v[52:67]
    ds_read_b64_tr_b16 v[48:49], v17 offset:16384
    ds_read_b64_tr_b16 v[50:51], v17 offset:16896
    s_waitcnt lgkmcnt(4)
    v_mfma_f32_32x32x16_bf16 v[68:83], v[36:39], v[84:87], 0
    ds_read_b64_tr_b16 v[28:29], v14 offset:18432
    ds_read_b64_tr_b16 v[30:31], v14 offset:18944
    v_mfma_f32_32x32x16_bf16 v[68:83], v[40:43], v[88:91], v[68:83]
    ds_read_b64_tr_b16 v[32:33], v15 offset:18432
    ds_read_b64_tr_b16 v[34:35], v15 offset:18944
    s_waitcnt lgkmcnt(4)
    v_mfma_f32_32x32x16_bf16 v[68:83], v[44:47], v[92:95], v[68:83]
    ds_read_b64_tr_b16 v[36:37], v16 offset:18432
    ds_read_b64_tr_b16 v[38:39], v16 offset:18944
    v_mfma_f32_32x32x16_bf16 v[68:83], v[48:51], v[96:99], v[68:83]
    ds_read_b64_tr_b16 v[40:41], v17 offset:18432
    ds_read_b64_tr_b16 v[42:43], v17 offset:18944
    v_mul_f32 v232, s50, v52
    v_exp_f32_e64 v232, v232 clamp
    v_max_f32 v52, s51, v52
    v_add_f32 v232, v232, v52
    v_mul_f32 v233, s50, v53
    v_exp_f32_e64 v233, v233 clamp
    s_waitcnt lgkmcnt(4)
    v_mfma_f32_32x32x16_bf16 v[68:83], v[28:31], v[100:103], v[68:83]
    ds_read_b64_tr_b16 v[44:45], v14 offset:20480
    ds_read_b64_tr_b16 v[46:47], v14 offset:20992
    v_max_f32 v53, s51, v53
    v_add_f32 v233, v233, v53
    v_cvt_pk_bf16_f32 v52, v232, v233
    v_mul_f32 v234, s50, v54
    v_exp_f32_e64 v234, v234 clamp
    v_max_f32 v54, s51, v54
    v_mfma_f32_32x32x16_bf16 v[68:83], v[32:35], v[104:107], v[68:83]
    ds_read_b64_tr_b16 v[48:49], v15 offset:20480
    ds_read_b64_tr_b16 v[50:51], v15 offset:20992
    v_add_f32 v234, v234, v54
    v_mul_f32 v235, s50, v55
    v_exp_f32_e64 v235, v235 clamp
    v_max_f32 v55, s51, v55
    v_add_f32 v235, v235, v55
    v_cvt_pk_bf16_f32 v53, v234, v235
    s_waitcnt lgkmcnt(4)
    v_mfma_f32_32x32x16_bf16 v[68:83], v[36:39], v[108:111], v[68:83]
    ds_read_b64_tr_b16 v[28:29], v16 offset:20480
    ds_read_b64_tr_b16 v[30:31], v16 offset:20992
    v_mul_f32 v232, s50, v56
    v_exp_f32_e64 v232, v232 clamp
    v_max_f32 v56, s51, v56
    v_add_f32 v232, v232, v56
    v_mul_f32 v233, s50, v57
    v_exp_f32_e64 v233, v233 clamp
    v_mfma_f32_32x32x16_bf16 v[68:83], v[40:43], v[112:115], v[68:83]
    ds_read_b64_tr_b16 v[32:33], v17 offset:20480
    ds_read_b64_tr_b16 v[34:35], v17 offset:20992
    v_max_f32 v57, s51, v57
    v_add_f32 v233, v233, v57
    v_cvt_pk_bf16_f32 v54, v232, v233
    v_mul_f32 v234, s50, v58
    v_exp_f32_e64 v234, v234 clamp
    v_max_f32 v58, s51, v58
    s_waitcnt lgkmcnt(4)
    v_mfma_f32_32x32x16_bf16 v[68:83], v[44:47], v[116:119], v[68:83]
    ds_read_b64_tr_b16 v[36:37], v14 offset:22528
    ds_read_b64_tr_b16 v[38:39], v14 offset:23040
    v_add_f32 v234, v234, v58
    v_mul_f32 v235, s50, v59
    v_exp_f32_e64 v235, v235 clamp
    v_max_f32 v59, s51, v59
    v_add_f32 v235, v235, v59
    v_cvt_pk_bf16_f32 v55, v234, v235
    v_mfma_f32_32x32x16_bf16 v[68:83], v[48:51], v[120:123], v[68:83]
    ds_read_b64_tr_b16 v[40:41], v15 offset:22528
    ds_read_b64_tr_b16 v[42:43], v15 offset:23040
    buffer_store_dwordx4 v[52:55], v18, s[36:39], s54 offen offset:0 sc1
    v_mul_f32 v232, s50, v60
    v_exp_f32_e64 v232, v232 clamp
    v_max_f32 v60, s51, v60
    v_add_f32 v232, v232, v60
    v_mul_f32 v233, s50, v61
    s_waitcnt lgkmcnt(4)
    v_mfma_f32_32x32x16_bf16 v[68:83], v[28:31], v[124:127], v[68:83]
    ds_read_b64_tr_b16 v[44:45], v16 offset:22528
    ds_read_b64_tr_b16 v[46:47], v16 offset:23040
    v_exp_f32_e64 v233, v233 clamp
    v_max_f32 v61, s51, v61
    v_add_f32 v233, v233, v61
    v_cvt_pk_bf16_f32 v56, v232, v233
    v_mul_f32 v234, s50, v62
    v_exp_f32_e64 v234, v234 clamp
    v_mfma_f32_32x32x16_bf16 v[68:83], v[32:35], v[128:131], v[68:83]
    ds_read_b64_tr_b16 v[48:49], v17 offset:22528
    ds_read_b64_tr_b16 v[50:51], v17 offset:23040
    v_max_f32 v62, s51, v62
    v_add_f32 v234, v234, v62
    v_mul_f32 v235, s50, v63
    v_exp_f32_e64 v235, v235 clamp
    v_max_f32 v63, s51, v63
    v_add_f32 v235, v235, v63
    s_waitcnt lgkmcnt(4)
    v_mfma_f32_32x32x16_bf16 v[68:83], v[36:39], v[132:135], v[68:83]
    ds_read_b64_tr_b16 v[28:29], v14 offset:24576
    ds_read_b64_tr_b16 v[30:31], v14 offset:25088
    v_cvt_pk_bf16_f32 v57, v234, v235
    v_mul_f32 v232, s50, v64
    v_exp_f32_e64 v232, v232 clamp
    v_max_f32 v64, s51, v64
    v_add_f32 v232, v232, v64
    v_mul_f32 v233, s50, v65
    v_mfma_f32_32x32x16_bf16 v[68:83], v[40:43], v[136:139], v[68:83]
    ds_read_b64_tr_b16 v[32:33], v15 offset:24576
    ds_read_b64_tr_b16 v[34:35], v15 offset:25088
    v_exp_f32_e64 v233, v233 clamp
    v_max_f32 v65, s51, v65
    v_add_f32 v233, v233, v65
    v_cvt_pk_bf16_f32 v58, v232, v233
    v_mul_f32 v234, s50, v66
    v_exp_f32_e64 v234, v234 clamp
    s_waitcnt lgkmcnt(4)
    v_mfma_f32_32x32x16_bf16 v[68:83], v[44:47], v[140:143], v[68:83]
    ds_read_b64_tr_b16 v[36:37], v16 offset:24576
    ds_read_b64_tr_b16 v[38:39], v16 offset:25088
    v_max_f32 v66, s51, v66
    v_add_f32 v234, v234, v66
    v_mul_f32 v235, s50, v67
    v_exp_f32_e64 v235, v235 clamp
    v_max_f32 v67, s51, v67
    v_add_f32 v235, v235, v67
    v_mfma_f32_32x32x16_bf16 v[68:83], v[48:51], v[144:147], v[68:83]
    ds_read_b64_tr_b16 v[40:41], v17 offset:24576
    ds_read_b64_tr_b16 v[42:43], v17 offset:25088
    v_cvt_pk_bf16_f32 v59, v234, v235
    buffer_store_dwordx4 v[56:59], v18, s[36:39], s54 offen offset:1024 sc1
    s_waitcnt lgkmcnt(4)
    v_mfma_f32_32x32x16_bf16 v[68:83], v[28:31], v[148:151], v[68:83]
    ds_read_b64_tr_b16 v[44:45], v14 offset:26624
    ds_read_b64_tr_b16 v[46:47], v14 offset:27136
    v_mfma_f32_32x32x16_bf16 v[68:83], v[32:35], v[152:155], v[68:83]
    ds_read_b64_tr_b16 v[48:49], v15 offset:26624
    ds_read_b64_tr_b16 v[50:51], v15 offset:27136
    s_waitcnt lgkmcnt(4)
    v_mfma_f32_32x32x16_bf16 v[68:83], v[36:39], v[156:159], v[68:83]
    ds_read_b64_tr_b16 v[28:29], v16 offset:26624
    ds_read_b64_tr_b16 v[30:31], v16 offset:27136
    v_mfma_f32_32x32x16_bf16 v[68:83], v[40:43], v[160:163], v[68:83]
    ds_read_b64_tr_b16 v[32:33], v17 offset:26624
    ds_read_b64_tr_b16 v[34:35], v17 offset:27136
    s_waitcnt lgkmcnt(4)
    v_mfma_f32_32x32x16_bf16 v[68:83], v[44:47], v[164:167], v[68:83]
    ds_read_b64_tr_b16 v[36:37], v14 offset:36864
    ds_read_b64_tr_b16 v[38:39], v14 offset:37376
    v_mfma_f32_32x32x16_bf16 v[68:83], v[48:51], v[168:171], v[68:83]
    ds_read_b64_tr_b16 v[40:41], v15 offset:36864
    ds_read_b64_tr_b16 v[42:43], v15 offset:37376
    s_waitcnt lgkmcnt(4)
    v_mfma_f32_32x32x16_bf16 v[68:83], v[28:31], v[172:175], v[68:83]
    ds_read_b64_tr_b16 v[44:45], v16 offset:36864
    ds_read_b64_tr_b16 v[46:47], v16 offset:37376
    v_mfma_f32_32x32x16_bf16 v[68:83], v[32:35], v[236:239], v[68:83]
    ds_read_b64_tr_b16 v[48:49], v17 offset:36864
    ds_read_b64_tr_b16 v[50:51], v17 offset:37376
    s_waitcnt lgkmcnt(4)
    v_mfma_f32_32x32x16_bf16 v[68:83], v[36:39], v[240:243], v[68:83]
    v_mfma_f32_32x32x16_bf16 v[68:83], v[40:43], v[244:247], v[68:83]
    s_waitcnt lgkmcnt(0)
    v_mfma_f32_32x32x16_bf16 v[68:83], v[44:47], v[248:251], v[68:83]
    v_mfma_f32_32x32x16_bf16 v[68:83], v[48:51], v[252:255], v[68:83]
    s_nop 11
    v_mul_f32 v232, s50, v68
    v_exp_f32_e64 v232, v232 clamp
    v_max_f32 v68, s51, v68
    v_add_f32 v232, v232, v68
    v_mul_f32 v233, s50, v69
    v_exp_f32_e64 v233, v233 clamp
    v_max_f32 v69, s51, v69
    v_add_f32 v233, v233, v69
    v_cvt_pk_bf16_f32 v68, v232, v233
    v_mul_f32 v234, s50, v70
    v_exp_f32_e64 v234, v234 clamp
    v_max_f32 v70, s51, v70
    v_add_f32 v234, v234, v70
    v_mul_f32 v235, s50, v71
    v_exp_f32_e64 v235, v235 clamp
    v_max_f32 v71, s51, v71
    v_add_f32 v235, v235, v71
    v_cvt_pk_bf16_f32 v69, v234, v235
    v_mul_f32 v232, s50, v72
    v_exp_f32_e64 v232, v232 clamp
    v_max_f32 v72, s51, v72
    v_add_f32 v232, v232, v72
    v_mul_f32 v233, s50, v73
    v_exp_f32_e64 v233, v233 clamp
    v_max_f32 v73, s51, v73
    v_add_f32 v233, v233, v73
    v_cvt_pk_bf16_f32 v70, v232, v233
    v_mul_f32 v234, s50, v74
    v_exp_f32_e64 v234, v234 clamp
    v_max_f32 v74, s51, v74
    v_add_f32 v234, v234, v74
    v_mul_f32 v235, s50, v75
    v_exp_f32_e64 v235, v235 clamp
    v_max_f32 v75, s51, v75
    v_add_f32 v235, v235, v75
    v_cvt_pk_bf16_f32 v71, v234, v235
    buffer_store_dwordx4 v[68:71], v18, s[36:39], s54 offen offset:2048 sc1
    v_mul_f32 v232, s50, v76
    v_exp_f32_e64 v232, v232 clamp
    v_max_f32 v76, s51, v76
    v_add_f32 v232, v232, v76
    v_mul_f32 v233, s50, v77
    v_exp_f32_e64 v233, v233 clamp
    v_max_f32 v77, s51, v77
    v_add_f32 v233, v233, v77
    v_cvt_pk_bf16_f32 v72, v232, v233
    v_mul_f32 v234, s50, v78
    v_exp_f32_e64 v234, v234 clamp
    v_max_f32 v78, s51, v78
    v_add_f32 v234, v234, v78
    v_mul_f32 v235, s50, v79
    v_exp_f32_e64 v235, v235 clamp
    v_max_f32 v79, s51, v79
    v_add_f32 v235, v235, v79
    v_cvt_pk_bf16_f32 v73, v234, v235
    v_mul_f32 v232, s50, v80
    v_exp_f32_e64 v232, v232 clamp
    v_max_f32 v80, s51, v80
    v_add_f32 v232, v232, v80
    v_mul_f32 v233, s50, v81
    v_exp_f32_e64 v233, v233 clamp
    v_max_f32 v81, s51, v81
    v_add_f32 v233, v233, v81
    v_cvt_pk_bf16_f32 v74, v232, v233
    v_mul_f32 v234, s50, v82
    v_exp_f32_e64 v234, v234 clamp
    v_max_f32 v82, s51, v82
    v_add_f32 v234, v234, v82
    v_mul_f32 v235, s50, v83
    v_exp_f32_e64 v235, v235 clamp
    v_max_f32 v83, s51, v83
    v_add_f32 v235, v235, v83
    v_cvt_pk_bf16_f32 v75, v234, v235
    buffer_store_dwordx4 v[72:75], v18, s[36:39], s54 offen offset:3072 sc1
    s_waitcnt vmcnt(0)
    buffer_store_dword v8, v9, s[36:39], 0 offen sc1
    s_cmp_lt_u32 s68, 7
    s_cbranch_scc1 L_amid
    s_setprio 0
    s_lshr_b32 s72, s69, 3
    s_and_b32 s65, s69, 7
    s_lshl3_add_u32 s65, s65, s99
    s_lshl_b32 s77, s65, 7
    s_add_u32 s77, s77, 12075008
    s_add_u32 s58, s24, s77
    s_addc_u32 s59, s25, 0
    s_lshr_b32 s77, s65, 1
    s_lshl2_add_u32 s77, s77, s72
    s_lshl_b32 s77, s77, 7
    s_add_u32 s77, s77, 12058624
    s_and_b32 s71, s99, 1
    s_lshl2_add_u32 s77, s71, s77
    s_add_u32 s77, s77, 16
    v_mov_b32 v9, s77
    v_mov_b32 v8, 1
    s_mul_i32 s72, s72, 7168
    s_mul_i32 s4, s65, 28672
    s_add_u32 s4, s4, s72
    s_add_u32 s4, s4, 9437184
    s_add_u32 s5, s4, 4096
    s_mul_i32 s40, s65, 143360
    s_add_u32 s40, s40, s72
    s_add_u32 s40, s40, 114688
    s_add_u32 s41, s40, 4096
    s_mov_b32 s82, 0
    s_mov_b32 s83, -1
    s_mov_b32 s51, 0x358637bd
    v_add_u32 v12, 120832, v18
    v_add_u32 v11, 38912, v18
    s_load_dwordx8 s[84:91], s[58:59], 0 glc
L_join:
    s_waitcnt lgkmcnt(0)
    s_and_b64 s[84:85], s[84:85], s[90:91]
    s_and_b64 s[84:85], s[84:85], s[88:89]
    s_and_b64 s[84:85], s[84:85], s[86:87]
    s_and_b32 s84, s84, s85
    s_and_b32 s84, s84, 1
    s_cbranch_scc0 L_poll_19
L_pend_20:
    buffer_load_dwordx4 v[84:87], v18, s[36:39], s4 offen offset:0 sc1
    buffer_load_dwordx4 v[88:91], v18, s[36:39], s4 offen offset:1024 sc1
    buffer_load_dwordx4 v[92:95], v18, s[36:39], s4 offen offset:2048 sc1
    buffer_load_dwordx4 v[96:99], v18, s[36:39], s4 offen offset:3072 sc1
    buffer_load_dwordx4 v[100:103], v18, s[36:39], s5 offen offset:0 sc1
    buffer_load_dwordx4 v[104:107], v18, s[36:39], s5 offen offset:1024 sc1
    buffer_load_dwordx4 v[108:111], v18, s[36:39], s5 offen offset:2048 sc1
    s_barrier
    ds_read_b128 v[52:55], v11 offset:0
    ds_read_b128 v[56:59], v11 offset:1024
    ds_read_b128 v[60:63], v11 offset:40960
    ds_read_b128 v[64:67], v11 offset:41984
    ds_read_b128 v[68:71], v12 offset:0
    ds_read_b128 v[72:75], v12 offset:1024
    ds_read_b128 v[76:79], v12 offset:40960
    ds_read_b128 v[80:83], v12 offset:41984
    s_waitcnt vmcnt(3) lgkmcnt(0)
    v_mfma_f32_32x32x16_bf16 v[140:155], v[52:55], v[84:87], 0
    v_mfma_f32_32x32x16_bf16 v[156:171], v[60:63], v[90:93], 0
    v_mfma_f32_32x32x16_bf16 v[140:155], v[56:59], v[88:91], v[140:155]
    v_mfma_f32_32x32x16_bf16 v[156:171], v[64:67], v[94:97], v[156:171]
    s_waitcnt vmcnt(0)
    v_mfma_f32_32x32x16_bf16 v[172:187], v[68:71], v[98:101], 0
    v_mfma_f32_32x32x16_bf16 v[188:203], v[76:79], v[104:107], 0
    v_mfma_f32_32x32x16_bf16 v[172:187], v[72:75], v[102:105], v[172:187]
    v_mfma_f32_32x32x16_bf16 v[188:203], v[80:83], v[108:111], v[188:203]
    s_nop 5
    v_add_f32 v228, s51, v152
    v_add_f32 v229, s51, v152
    v_add_f32 v230, s51, v156
    v_add_f32 v231, s51, v156
    v_permlane32_swap_b32 v228, v229
    s_nop 0
    v_permlane32_swap_b32 v230, v231
    v_rcp_f32 v229, v229
    v_rcp_f32 v230, v230
    v_mul_f32 v140, v140, v229
    v_mul_f32 v141, v141, v229
    v_cvt_pk_bf16_f32 v84, v140, v141
    v_mul_f32 v142, v142, v229
    v_mul_f32 v143, v143, v229
    v_cvt_pk_bf16_f32 v85, v142, v143
    v_mul_f32 v144, v144, v229
    v_mul_f32 v145, v145, v229
    v_cvt_pk_bf16_f32 v86, v144, v145
    v_mul_f32 v146, v146, v229
    v_mul_f32 v147, v147, v229
    v_cvt_pk_bf16_f32 v87, v146, v147
    buffer_store_dwordx4 v[84:87], v18, s[36:39], s40 offen offset:0 sc1
    v_mul_f32 v148, v148, v229
    v_mul_f32 v149, v149, v229
    v_cvt_pk_bf16_f32 v88, v148, v149
    v_mul_f32 v150, v150, v229
    v_mul_f32 v151, v151, v229
    v_cvt_pk_bf16_f32 v89, v150, v151
    v_mul_f32 v152, v152, v229
    v_mul_f32 v153, v153, v229
    v_cvt_pk_bf16_f32 v90, v152, v153
    v_mul_f32 v154, v154, v229
    v_mul_f32 v155, v155, v229
    v_cvt_pk_bf16_f32 v91, v154, v155
    v_mul_f32 v156, v156, v230
    v_mul_f32 v157, v157, v230
    v_cvt_pk_bf16_f32 v232, v156, v157
    v_mul_f32 v158, v158, v230
    v_mul_f32 v159, v159, v230
    v_cvt_pk_bf16_f32 v233, v158, v159
    v_cndmask_b32 v90, v90, v232, s[82:83]
    v_cndmask_b32 v91, v91, v233, s[82:83]
    buffer_store_dwordx4 v[88:91], v18, s[36:39], s40 offen offset:1024 sc1
    v_mul_f32 v160, v160, v230
    v_mul_f32 v161, v161, v230
    v_cvt_pk_bf16_f32 v92, v160, v161
    v_mul_f32 v162, v162, v230
    v_mul_f32 v163, v163, v230
    v_cvt_pk_bf16_f32 v93, v162, v163
    v_mul_f32 v164, v164, v230
    v_mul_f32 v165, v165, v230
    v_cvt_pk_bf16_f32 v94, v164, v165
    v_mul_f32 v166, v166, v230
    v_mul_f32 v167, v167, v230
    v_cvt_pk_bf16_f32 v95, v166, v167
    buffer_store_dwordx4 v[92:95], v18, s[36:39], s40 offen offset:2048 sc1
    v_mul_f32 v168, v168, v230
    v_mul_f32 v169, v169, v230
    v_cvt_pk_bf16_f32 v96, v168, v169
    v_mul_f32 v170, v170, v230
    v_mul_f32 v171, v171, v230
    v_cvt_pk_bf16_f32 v97, v170, v171
    v_add_f32 v228, s51, v184
    v_add_f32 v229, s51, v184
    v_add_f32 v230, s51, v188
    v_add_f32 v231, s51, v188
    v_permlane32_swap_b32 v228, v229
    s_nop 0
    v_permlane32_swap_b32 v230, v231
    v_rcp_f32 v229, v229
    v_rcp_f32 v230, v230
    v_mul_f32 v172, v172, v229
    v_mul_f32 v173, v173, v229
    v_cvt_pk_bf16_f32 v98, v172, v173
    v_mul_f32 v174, v174, v229
    v_mul_f32 v175, v175, v229
    v_cvt_pk_bf16_f32 v99, v174, v175
    buffer_store_dwordx4 v[96:99], v18, s[36:39], s40 offen offset:3072 sc1
    v_mul_f32 v176, v176, v229
    v_mul_f32 v177, v177, v229
    v_cvt_pk_bf16_f32 v100, v176, v177
    v_mul_f32 v178, v178, v229
    v_mul_f32 v179, v179, v229
    v_cvt_pk_bf16_f32 v101, v178, v179
    v_mul_f32 v180, v180, v229
    v_mul_f32 v181, v181, v229
    v_cvt_pk_bf16_f32 v102, v180, v181
    v_mul_f32 v182, v182, v229
    v_mul_f32 v183, v183, v229
    v_cvt_pk_bf16_f32 v103, v182, v183
    buffer_store_dwordx4 v[100:103], v18, s[36:39], s41 offen offset:0 sc1
    v_mul_f32 v184, v184, v229
    v_mul_f32 v185, v185, v229
    v_cvt_pk_bf16_f32 v104, v184, v185
    v_mul_f32 v186, v186, v229
    v_mul_f32 v187, v187, v229
    v_cvt_pk_bf16_f32 v105, v186, v187
    v_mul_f32 v188, v188, v230
    v_mul_f32 v189, v189, v230
    v_cvt_pk_bf16_f32 v232, v188, v189
    v_mul_f32 v190, v190, v230
    v_mul_f32 v191, v191, v230
    v_cvt_pk_bf16_f32 v233, v190, v191
    v_cndmask_b32 v104, v104, v232, s[82:83]
    v_cndmask_b32 v105, v105, v233, s[82:83]
    v_mul_f32 v192, v192, v230
    v_mul_f32 v193, v193, v230
    v_cvt_pk_bf16_f32 v106, v192, v193
    v_mul_f32 v194, v194, v230
    v_mul_f32 v195, v195, v230
    v_cvt_pk_bf16_f32 v107, v194, v195
    buffer_store_dwordx4 v[104:107], v18, s[36:39], s41 offen offset:1024 sc1
    v_mul_f32 v196, v196, v230
    v_mul_f32 v197, v197, v230
    v_cvt_pk_bf16_f32 v108, v196, v197
    v_mul_f32 v198, v198, v230
    v_mul_f32 v199, v199, v230
    v_cvt_pk_bf16_f32 v109, v198, v199
    v_mul_f32 v200, v200, v230
    v_mul_f32 v201, v201, v230
    v_cvt_pk_bf16_f32 v110, v200, v201
    v_mul_f32 v202, v202, v230
    v_mul_f32 v203, v203, v230
    v_cvt_pk_bf16_f32 v111, v202, v203
    buffer_store_dwordx4 v[108:111], v18, s[36:39], s41 offen offset:2048 sc1
    s_waitcnt vmcnt(0)
    buffer_store_dword v8, v9, s[36:39], 0 offen sc1
    s_endpgm
L_B:
    s_bfe_u32 s70, s2, 0x10002
    s_lshl1_add_u32 s69, s65, s70
    s_and_b32 s66, s68, 3
    s_lshl2_add_u32 s66, s70, s66
    s_lshr_b32 s67, s68, 2
    s_movk_i32 s70, 3584
    s_cselect_b32 s56, 2688, s70
    s_cselect_b32 s77, 6, 7
    s_cbranch_scc1 L_Bck
    s_lshl_b32 s62, s66, 7
    s_add_u32 s63, s62, 1024
    s_add_u32 s64, s62, 2048
    s_branch L_Bcd
L_Bck:
    s_mul_i32 s62, s66, 112
    s_add_u32 s63, s62, 1792
    s_addk_i32 s62, 896
    s_lshl_b32 s64, s66, 7
    s_cmp_eq_u32 s66, 7
    s_cselect_b32 s64, 0x200000, s64
L_Bcd:
    s_mul_i32 s70, s3, s56
    s_lshl_b32 s70, s70, 4
    s_lshl_b32 s74, s66, 6
    s_addk_i32 s74, 3072
    s_add_u32 s62, s62, s70
    s_add_u32 s63, s63, s70
    s_add_u32 s64, s64, s70
    s_add_u32 s74, s74, s70
    s_lshl_b32 s71, s56, 6
    s_mul_i32 s91, s75, s71
    s_add_u32 s75, s75, 1
    s_cmp_eq_u32 s75, 7
    s_cselect_b32 s75, 0, s75
    s_mul_i32 s92, s75, s71
    s_add_u32 s75, s75, 1
    s_cmp_eq_u32 s75, 7
    s_cselect_b32 s75, 0, s75
    s_mul_i32 s93, s75, s71
    s_add_u32 s75, s75, 1
    s_cmp_eq_u32 s75, 7
    s_cselect_b32 s75, 0, s75
    s_mul_i32 s94, s75, s71
    s_add_u32 s75, s75, 1
    s_cmp_eq_u32 s75, 7
    s_cselect_b32 s75, 0, s75
    s_mul_i32 s95, s75, s71
    s_add_u32 s75, s75, 1
    s_cmp_eq_u32 s75, 7
    s_cselect_b32 s75, 0, s75
    s_mul_i32 s96, s75, s71
    s_add_u32 s75, s75, 1
    s_cmp_eq_u32 s75, 7
    s_cselect_b32 s75, 0, s75
    s_mul_i32 s97, s75, s71
    v_and_b32 v32, 2, v6
    v_lshlrev_b32 v32, 1, v32
    v_xor_b32 v32, v7, v32
    v_lshlrev_b32 v33, 4, v32
    v_mul_u32_u24 v34, 896, v6
    v_add_u32 v12, v34, v33
    v_add_u32 v13, 6144, v12
    s_lshl_b32 s70, s56, 3
    s_addk_i32 s70, -1024
    v_mul_u32_u24 v34, s56, v6
    v_add_u32 v10, v34, v33
    v_add_u32 v11, s70, v10
    v_min_u32 v32, s77, v32
    v_lshl_add_u32 v8, v32, 4, v34
    v_add_u32 v9, s70, v8
    s_waitcnt lgkmcnt(0)
    s_cmp_ge_u32 s2, 252
    s_cbranch_scc1 L_init
L_noinit:
    s_lshr_b32 s70, s2, 3
    s_and_b32 s71, s2, 3
    s_lshl2_add_u32 s70, s70, s71
    s_lshl2_add_u32 s70, s70, s3
    s_min_u32 s70, s70, 447
    s_bfe_u32 s71, s2, 0x10002
    s_mul_i32 s72, s70, 2688
    s_mul_i32 s77, s71, 384
    s_add_u32 s72, s72, s77
    s_add_u32 s82, s6, s72
    s_addc_u32 s83, s7, 0
    s_mul_i32 s72, s70, 3584
    s_lshl_b32 s77, s71, 9
    s_add_u32 s77, s72, s77
    s_add_u32 s84, s12, s77
    s_addc_u32 s85, s13, 0
    s_lshl_b32 s77, s71, 8
    s_add_u32 s77, s72, s77
    s_addk_i32 s77, 3072
    s_add_u32 s86, s12, s77
    s_addc_u32 s87, s13, 0
    s_lshl1_add_u32 s70, s70, s71
    s_lshl_b32 s72, s70, 9
    s_add_u32 s88, s16, s72
    s_addc_u32 s89, s17, 0
    s_lshl_b32 s72, s70, 8
    s_add_u32 s72, s72, 1376256
    s_add_u32 s14, s16, s72
    s_addc_u32 s15, s17, 0
    s_mul_i32 s72, s70, 448
    s_and_b32 s72, s72, 0xffffff80
    s_add_u32 s58, s8, s72
    s_addc_u32 s59, s9, 0
    s_load_dwordx2 s[80:81], s[82:83], 956
    s_load_dwordx2 s[80:81], s[82:83], 1084
    s_load_dwordx2 s[80:81], s[82:83], 1212
    s_load_dwordx2 s[80:81], s[82:83], 1340
    s_load_dwordx2 s[80:81], s[84:85], 60
    s_load_dwordx2 s[80:81], s[84:85], 188
    s_load_dwordx2 s[80:81], s[84:85], 316
    s_cmp_eq_u32 s67, 0
    s_cselect_b32 s32, s12, s6
    s_cselect_b32 s33, s13, s7
    s_mul_i32 s34, s56, 448
    s_mov_b32 s35, 0x20000
    s_cmp_lt_u32 s68, 7
    s_mov_b32 s40, s16
    s_mov_b32 s41, s17
    s_cselect_b32 s42, 1605632, 0
    s_mov_b32 s43, 0x20000
    s_mov_b32 s44, s8
    s_mov_b32 s45, s9
    s_cselect_b32 s46, 401408, 0
    s_mov_b32 s47, 0x20000
    s_mov_b32 s36, s24
    s_mov_b32 s37, s25
    s_mov_b32 s38, 15728640
    s_mov_b32 s39, 0x20000
    s_mov_b64 s[8:9], s[22:23]
    s_mov_b32 s28, s4
    s_mov_b32 s29, s5
    s_mov_b32 s30, 1835008
    s_mov_b32 s31, 0x20000
    s_mov_b32 s48, s20
    s_mov_b32 s49, s21
    s_mov_b32 s50, 1835008
    s_mov_b32 s51, 0x20000
    s_mov_b32 s52, s18
    s_mov_b32 s53, s19
    s_mov_b32 s54, 896
    s_mov_b32 s55, 0x20000
    s_lshl_b32 s70, s68, 7
    s_and_b32 s11, s2, 4
    s_add_u32 s11, s11, s3
    s_mul_i32 s12, s11, 57344
    s_add_u32 s12, s12, s70
    s_mul_i32 s7, s11, 28672
    s_add_u32 s7, s7, s70
    s_add_u32 s7, s7, 1376256
    s_xor_b32 s6, s11, 4
    s_mul_i32 s4, s6, 57344
    s_add_u32 s4, s4, s70
    s_mul_i32 s5, s6, 28672
    s_add_u32 s5, s5, s70
    s_add_u32 s5, s5, 1376256
    s_mul_i32 s76, s3, 100352
    s_add_u32 s76, s76, s70
    s_mov_b32 s10, 0xffff0000
    s_mov_b32 s16, 32768
    s_mov_b32 s17, 65536
    s_lshl_b32 s18, s11, 11
    s_sub_u32 s18, 98304, s18
    s_mul_i32 s19, s3, 7168
    s_add_u32 s19, s19, 114688
    s_lshl_b32 s20, s11, 12
    s_sub_u32 s19, s19, s20
    s_add_u32 s20, s19, 4096
    s_lshl2_add_u32 s21, s2, s3
    s_lshl_b32 s21, s21, 11
    s_add_u32 s21, s21, 13631488
    s_lshl2_add_u32 s22, s68, 32
    s_lshr_b32 s60, s3, 1
    s_lshl1_add_u32 s60, s69, s60
    s_and_b32 s71, s3, 1
    s_lshl_b32 s71, s71, 6
    s_add_u32 s78, s70, s71
    s_mul_i32 s61, s60, 28672
    s_add_u32 s61, s61, s78
    s_add_u32 s79, s61, 14336
    v_lshrrev_b32 v7, 2, v0
    v_and_b32 v6, 3, v0
    v_lshlrev_b32 v6, 4, v6
    v_mul_u32_u24 v4, 896, v7
    v_add_u32 v4, v4, v6
    v_mul_u32_u24 v1, 3584, v7
    v_add_u32 v1, v1, v6
    v_mul_u32_u24 v17, 68, v6
    v_lshl_add_u32 v17, v7, 4, v17
    v_add_u32 v17, s26, v17
    v_add_u32 v17, 23552, v17
    v_lshrrev_b32 v32, 5, v0
    v_bfe_u32 v33, v0, 2, 2
    v_lshrrev_b32 v34, 1, v6
    v_bfe_u32 v35, v0, 4, 1
    v_lshl_add_u32 v34, v35, 5, v34
    v_and_b32 v35, 2, v33
    v_lshlrev_b32 v35, 5, v35
    v_xor_b32 v34, v34, v35
    v_lshl_add_u32 v32, v32, 2, v33
    v_lshl_add_u32 v32, v32, 7, v34
    v_xor_b32 v32, s71, v32
    v_add_u32 v14, s26, v32
    v_xor_b32 v15, 64, v14
    s_lshl_b32 s77, s11, 12
    s_xor_b32 s70, s60, 0
    s_mul_i32 s70, s70, 143360
    s_add_u32 s70, s70, s77
    v_add_u32 v2, s70, v18
    s_xor_b32 s70, s60, 1
    s_mul_i32 s70, s70, 143360
    s_add_u32 s70, s70, s77
    v_add_u32 v3, s70, v18
    s_xor_b32 s70, s60, 2
    s_mul_i32 s70, s70, 143360
    s_add_u32 s70, s70, s77
    v_add_u32 v20, s70, v18
    s_xor_b32 s70, s60, 3
    s_mul_i32 s70, s70, 143360
    s_add_u32 s70, s70, s77
    v_add_u32 v21, s70, v18
    s_xor_b32 s70, s3, 0
    s_mul_i32 s70, s70, 40960
    s_add_u32 s70, s70, 23552
    v_add_u32 v24, s70, v18
    s_xor_b32 s70, s3, 1
    s_mul_i32 s70, s70, 40960
    s_add_u32 s70, s70, 23552
    v_add_u32 v25, s70, v18
    s_xor_b32 s70, s3, 2
    s_mul_i32 s70, s70, 40960
    s_add_u32 s70, s70, 23552
    v_add_u32 v26, s70, v18
    s_xor_b32 s70, s3, 3
    s_mul_i32 s70, s70, 40960
    s_add_u32 s70, s70, 23552
    v_add_u32 v27, s70, v18
    s_load_dwordx2 s[80:81], s[84:85], 444
    s_cmp_ge_u32 s2, 252
    s_cbranch_scc1 L_go
L_gone:
    s_cmp_lg_u32 s67, 0
    s_cbranch_scc1 L_Bk
    s_barrier
    s_add_u32 m0, s26, 28672
    s_add_u32 s27, s62, s91
    buffer_load_dwordx4 v8, s[32:35], s27 offen offset:0 lds
    buffer_load_dwordx4 v9, s[32:35], s27 offen offset:1024 lds
    s_addk_i32 m0, 2048
    s_add_u32 s27, s62, s92
    buffer_load_dwordx4 v8, s[32:35], s27 offen offset:0 lds
    buffer_load_dwordx4 v9, s[32:35], s27 offen offset:1024 lds
    s_addk_i32 m0, 2048
    s_add_u32 s27, s62, s93
    buffer_load_dwordx4 v8, s[32:35], s27 offen offset:0 lds
    buffer_load_dwordx4 v9, s[32:35], s27 offen offset:1024 lds
    s_addk_i32 m0, 2048
    s_add_u32 s27, s62, s94
    buffer_load_dwordx4 v8, s[32:35], s27 offen offset:0 lds
    buffer_load_dwordx4 v9, s[32:35], s27 offen offset:1024 lds
    s_addk_i32 m0, 2048
    s_add_u32 s27, s62, s95
    buffer_load_dwordx4 v8, s[32:35], s27 offen offset:0 lds
    buffer_load_dwordx4 v9, s[32:35], s27 offen offset:1024 lds
    s_addk_i32 m0, 2048
    s_add_u32 s27, s62, s96
    buffer_load_dwordx4 v8, s[32:35], s27 offen offset:0 lds
    buffer_load_dwordx4 v9, s[32:35], s27 offen offset:1024 lds
    s_add_u32 m0, s26, 0
    s_add_u32 s27, s62, s97
    buffer_load_dwordx4 v8, s[32:35], s27 offen offset:0 lds
    buffer_load_dwordx4 v9, s[32:35], s27 offen offset:1024 lds
    s_waitcnt vmcnt(12)
    s_barrier
    s_addk_i32 m0, 2048
    s_add_u32 s27, s63, s91
    buffer_load_dwordx4 v8, s[32:35], s27 offen offset:0 lds
    buffer_load_dwordx4 v9, s[32:35], s27 offen offset:1024 lds
    s_addk_i32 m0, 2048
    s_add_u32 s27, s63, s92
    buffer_load_dwordx4 v8, s[32:35], s27 offen offset:0 lds
    s_waitcnt vmcnt(13)
    s_barrier
    buffer_load_dwordx4 v9, s[32:35], s27 offen offset:1024 lds
    s_addk_i32 m0, 2048
    s_add_u32 s27, s63, s93
    buffer_load_dwordx4 v8, s[32:35], s27 offen offset:0 lds
    buffer_load_dwordx4 v9, s[32:35], s27 offen offset:1024 lds
    s_waitcnt vmcnt(12)
    s_barrier
    s_addk_i32 m0, 2048
    s_add_u32 s27, s63, s94
    buffer_load_dwordx4 v8, s[32:35], s27 offen offset:0 lds
    buffer_load_dwordx4 v9, s[32:35], s27 offen offset:1024 lds
    s_addk_i32 m0, 2048
    s_add_u32 s27, s63, s95
    buffer_load_dwordx4 v8, s[32:35], s27 offen offset:0 lds
    buffer_load_dwordx4 v9, s[32:35], s27 offen offset:1024 lds
    s_addk_i32 m0, 2048
    s_add_u32 s27, s63, s96
    buffer_load_dwordx4 v8, s[32:35], s27 offen offset:0 lds
    buffer_load_dwordx4 v9, s[32:35], s27 offen offset:1024 lds
    s_waitcnt vmcnt(12)
    s_barrier
    s_addk_i32 m0, 2048
    s_add_u32 s27, s63, s97
    buffer_load_dwordx4 v8, s[32:35], s27 offen offset:0 lds
    buffer_load_dwordx4 v9, s[32:35], s27 offen offset:1024 lds
    s_addk_i32 m0, 2048
    s_add_u32 s27, s64, s91
    buffer_load_dwordx4 v10, s[32:35], s27 offen offset:0 lds
    buffer_load_dwordx4 v11, s[32:35], s27 offen offset:1024 lds
    s_addk_i32 m0, 2048
    s_add_u32 s27, s64, s92
    buffer_load_dwordx4 v10, s[32:35], s27 offen offset:0 lds
    buffer_load_dwordx4 v11, s[32:35], s27 offen offset:1024 lds
    s_addk_i32 m0, 2048
    s_add_u32 s27, s64, s93
    buffer_load_dwordx4 v10, s[32:35], s27 offen offset:0 lds
    buffer_load_dwordx4 v11, s[32:35], s27 offen offset:1024 lds
    s_addk_i32 m0, 2048
    s_add_u32 s27, s64, s94
    buffer_load_dwordx4 v10, s[32:35], s27 offen offset:0 lds
    s_waitcnt vmcnt(13)
    s_barrier
    s_waitcnt vmcnt(9)
    buffer_load_dwordx4 v11, s[32:35], s27 offen offset:1024 lds
    s_addk_i32 m0, 2048
    s_add_u32 s27, s64, s95
    s_waitcnt vmcnt(9)
    buffer_load_dwordx4 v10, s[32:35], s27 offen offset:0 lds
    s_waitcnt vmcnt(9)
    buffer_load_dwordx4 v11, s[32:35], s27 offen offset:1024 lds
    s_addk_i32 m0, 2048
    s_add_u32 s27, s64, s96
    s_waitcnt vmcnt(9)
    buffer_load_dwordx4 v10, s[32:35], s27 offen offset:0 lds
    s_waitcnt vmcnt(9)
    buffer_load_dwordx4 v11, s[32:35], s27 offen offset:1024 lds
    s_addk_i32 m0, 2048
    s_add_u32 s27, s64, s97
    s_waitcnt vmcnt(9)
    buffer_load_dwordx4 v10, s[32:35], s27 offen offset:0 lds
    s_waitcnt vmcnt(9)
    buffer_load_dwordx4 v11, s[32:35], s27 offen offset:1024 lds
    s_addk_i32 m0, 2048
    s_add_u32 s27, s74, s91
    s_waitcnt vmcnt(8)
    buffer_load_dwordx4 v1, s[32:35], s27 offen offset:0 lds
    s_addk_i32 m0, 1024
    s_add_u32 s27, s74, s92
    s_waitcnt vmcnt(7)
    buffer_load_dwordx4 v1, s[32:35], s27 offen offset:0 lds
    s_addk_i32 m0, 1024
    s_add_u32 s27, s74, s93
    s_waitcnt vmcnt(6)
    buffer_load_dwordx4 v1, s[32:35], s27 offen offset:0 lds
    s_barrier
    s_addk_i32 m0, 1024
    s_add_u32 s27, s74, s94
    s_waitcnt vmcnt(5)
    buffer_load_dwordx4 v1, s[32:35], s27 offen offset:0 lds
    s_addk_i32 m0, 1024
    s_add_u32 s27, s74, s95
    s_waitcnt vmcnt(4)
    buffer_load_dwordx4 v1, s[32:35], s27 offen offset:0 lds
    s_addk_i32 m0, 1024
    s_add_u32 s27, s74, s96
    s_waitcnt vmcnt(4)
    buffer_load_dwordx4 v1, s[32:35], s27 offen offset:0 lds
    s_addk_i32 m0, 1024
    s_add_u32 s27, s74, s97
    s_waitcnt vmcnt(4)
    buffer_load_dwordx4 v1, s[32:35], s27 offen offset:0 lds
    s_lshl2_add_u32 s72, s2, s3
    s_mul_i32 s70, s72, 25
    s_mul_i32 s71, s72, 7
    v_min_u32 v66, 24, v0
    v_add_lshl_u32 v66, v66, s70, 7
    v_min_u32 v67, 6, v0
    v_add_lshl_u32 v67, v67, s71, 7
    buffer_load_dword v66, v66, s[40:43], 0 offen
    buffer_load_dword v67, v67, s[44:47], 0 offen
    s_waitcnt vmcnt(2)
    s_barrier
    s_lshl2_add_u32 s70, s69, s3
    s_lshl_b32 s70, s70, 7
    s_add_u32 s70, s70, 12058624
    s_add_u32 s14, s24, s70
    s_addc_u32 s15, s25, 0
    s_xor_b32 s70, s70, 512
    s_add_u32 s92, s24, s70
    s_addc_u32 s93, s25, 0
    s_sub_u32 s94, s6, s11
    s_lshl_b32 s95, s94, 11
    s_add_u32 s95, s95, s18
    s_lshl_b32 s94, s94, 12
    s_add_u32 s94, s94, s17
    s_addk_i32 m0, 2048
    s_add_u32 s13, s12, 0
    buffer_load_dwordx4 v12, s[40:43], s13 offen offset:0 lds
    buffer_load_dwordx4 v13, s[40:43], s13 offen offset:1024 lds
    s_add_u32 m0, s26, 0
    s_addk_i32 s13, 14336
    buffer_load_dwordx4 v12, s[40:43], s13 offen offset:0 lds
    buffer_load_dwordx4 v13, s[40:43], s13 offen offset:1024 lds
    s_addk_i32 m0, 2048
    s_addk_i32 s13, 14336
    buffer_load_dwordx4 v12, s[40:43], s13 offen offset:0 lds
    s_waitcnt vmcnt(6)
    buffer_load_dwordx4 v13, s[40:43], s13 offen offset:1024 lds
    s_addk_i32 m0, 2048
    s_addk_i32 s13, 14336
    buffer_load_dwordx4 v12, s[40:43], s13 offen offset:0 lds
    buffer_load_dwordx4 v13, s[40:43], s13 offen offset:1024 lds
    s_addk_i32 m0, 2048
    s_add_u32 s13, s12, 458752
    buffer_load_dwordx4 v12, s[40:43], s13 offen offset:0 lds
    s_waitcnt vmcnt(9)
    buffer_load_dwordx4 v13, s[40:43], s13 offen offset:1024 lds
    s_addk_i32 m0, 2048
    s_addk_i32 s13, 14336
    s_waitcnt vmcnt(9)
    buffer_load_dwordx4 v12, s[40:43], s13 offen offset:0 lds
    s_waitcnt vmcnt(9)
    buffer_load_dwordx4 v13, s[40:43], s13 offen offset:1024 lds
    ds_read_b64_tr_b16 v[144:145], v14 offset:38912
    ds_read_b64_tr_b16 v[146:147], v14 offset:39936
    ds_read_b64_tr_b16 v[148:149], v15 offset:38912
    ds_read_b64_tr_b16 v[150:151], v15 offset:39936
    s_addk_i32 m0, 2048
    s_addk_i32 s13, 14336
    s_waitcnt vmcnt(9)
    buffer_load_dwordx4 v12, s[40:43], s13 offen offset:0 lds
    s_waitcnt vmcnt(9)
    buffer_load_dwordx4 v13, s[40:43], s13 offen offset:1024 lds
    ds_read_b64_tr_b16 v[152:153], v14 offset:0
    ds_read_b64_tr_b16 v[154:155], v14 offset:1024
    ds_read_b64_tr_b16 v[156:157], v15 offset:0
    ds_read_b64_tr_b16 v[158:159], v15 offset:1024
    s_addk_i32 m0, 2048
    s_addk_i32 s13, 14336
    s_waitcnt vmcnt(9)
    buffer_load_dwordx4 v12, s[40:43], s13 offen offset:0 lds
    s_waitcnt vmcnt(9)
    buffer_load_dwordx4 v13, s[40:43], s13 offen offset:1024 lds
    ds_read_b64_tr_b16 v[160:161], v14 offset:2048
    ds_read_b64_tr_b16 v[162:163], v14 offset:3072
    ds_read_b64_tr_b16 v[164:165], v15 offset:2048
    ds_read_b64_tr_b16 v[166:167], v15 offset:3072
    s_addk_i32 m0, 2048
    s_add_u32 s13, s12, 917504
    s_waitcnt vmcnt(9)
    buffer_load_dwordx4 v12, s[40:43], s13 offen offset:0 lds
    s_waitcnt vmcnt(9)
    buffer_load_dwordx4 v13, s[40:43], s13 offen offset:1024 lds
    ds_read_b64_tr_b16 v[168:169], v14 offset:4096
    ds_read_b64_tr_b16 v[170:171], v14 offset:5120
    ds_read_b64_tr_b16 v[172:173], v15 offset:4096
    ds_read_b64_tr_b16 v[174:175], v15 offset:5120
    s_addk_i32 m0, 2048
    s_addk_i32 s13, 14336
    s_waitcnt vmcnt(9)
    buffer_load_dwordx4 v12, s[40:43], s13 offen offset:0 lds
    s_waitcnt vmcnt(9)
    buffer_load_dwordx4 v13, s[40:43], s13 offen offset:1024 lds
    ds_read_b64_tr_b16 v[176:177], v14 offset:6144
    ds_read_b64_tr_b16 v[178:179], v14 offset:7168
    ds_read_b64_tr_b16 v[180:181], v15 offset:6144
    ds_read_b64_tr_b16 v[182:183], v15 offset:7168
    s_load_dwordx4 s[84:87], s[14:15], 0 glc
    s_waitcnt lgkmcnt(15)
    s_waitcnt lgkmcnt(12)
    s_addk_i32 m0, -16384
    s_addk_i32 s13, 14336
    s_waitcnt vmcnt(9)
    buffer_load_dwordx4 v12, s[40:43], s13 offen offset:0 lds
    s_waitcnt vmcnt(9)
    buffer_load_dwordx4 v13, s[40:43], s13 offen offset:1024 lds
    ds_read_b64_tr_b16 v[184:185], v14 offset:8192
    ds_read_b64_tr_b16 v[186:187], v14 offset:9216
    ds_read_b64_tr_b16 v[188:189], v15 offset:8192
    ds_read_b64_tr_b16 v[190:191], v15 offset:9216
    s_waitcnt lgkmcnt(12)
    s_addk_i32 m0, 2048
    s_addk_i32 s13, 14336
    s_waitcnt vmcnt(9)
    buffer_load_dwordx4 v12, s[40:43], s13 offen offset:0 lds
    s_waitcnt vmcnt(9)
    buffer_load_dwordx4 v13, s[40:43], s13 offen offset:1024 lds
    ds_read_b64_tr_b16 v[192:193], v14 offset:10240
    ds_read_b64_tr_b16 v[194:195], v14 offset:11264
    ds_read_b64_tr_b16 v[196:197], v15 offset:10240
    ds_read_b64_tr_b16 v[198:199], v15 offset:11264
    s_waitcnt lgkmcnt(12)
    s_addk_i32 m0, 2048
    s_add_u32 s13, s7, 0
    s_waitcnt vmcnt(9)
    buffer_load_dwordx4 v12, s[40:43], s13 offen offset:0 lds
    s_waitcnt vmcnt(9)
    buffer_load_dwordx4 v13, s[40:43], s13 offen offset:1024 lds
    ds_read_b64_tr_b16 v[200:201], v14 offset:12288
    ds_read_b64_tr_b16 v[202:203], v14 offset:13312
    ds_read_b64_tr_b16 v[204:205], v15 offset:12288
    ds_read_b64_tr_b16 v[206:207], v15 offset:13312
    s_waitcnt lgkmcnt(12)
    s_addk_i32 m0, 2048
    s_addk_i32 s13, 14336
    s_waitcnt vmcnt(9)
    buffer_load_dwordx4 v12, s[40:43], s13 offen offset:0 lds
    s_waitcnt vmcnt(9)
    buffer_load_dwordx4 v13, s[40:43], s13 offen offset:1024 lds
    ds_read_b64_tr_b16 v[208:209], v14 offset:14336
    ds_read_b64_tr_b16 v[210:211], v14 offset:15360
    ds_read_b64_tr_b16 v[212:213], v15 offset:14336
    ds_read_b64_tr_b16 v[214:215], v15 offset:15360
    s_waitcnt lgkmcnt(0)
    s_and_b64 s[84:85], s[84:85], s[86:87]
    s_and_b32 s84, s84, s85
    s_and_b32 s84, s84, 1
    s_cbranch_scc0 L_poll_3
L_pend_4:
    s_load_dwordx4 s[84:87], s[14:15], 0 glc
    s_waitcnt vmcnt(9)
    buffer_load_dwordx4 v[96:99], v21, s[36:39], 0 offen offset:0 sc1
    s_waitcnt vmcnt(9)
    buffer_load_dwordx4 v[100:103], v20, s[36:39], 0 offen offset:0 sc1
    ds_read_b64_tr_b16 v[216:217], v14 offset:16384
    ds_read_b64_tr_b16 v[218:219], v14 offset:17408
    ds_read_b64_tr_b16 v[220:221], v15 offset:16384
    ds_read_b64_tr_b16 v[222:223], v15 offset:17408
    s_waitcnt vmcnt(9)
    buffer_load_dwordx4 v[104:107], v21, s[36:39], 0 offen offset:1024 sc1
    s_waitcnt vmcnt(9)
    buffer_load_dwordx4 v[108:111], v20, s[36:39], 0 offen offset:1024 sc1
    ds_read_b64_tr_b16 v[224:225], v14 offset:0
    ds_read_b64_tr_b16 v[226:227], v14 offset:1024
    ds_read_b64_tr_b16 v[228:229], v15 offset:0
    ds_read_b64_tr_b16 v[230:231], v15 offset:1024
    s_waitcnt vmcnt(9)
    buffer_load_dwordx4 v[112:115], v21, s[36:39], 0 offen offset:2048 sc1
    s_waitcnt vmcnt(9)
    buffer_load_dwordx4 v[116:119], v20, s[36:39], 0 offen offset:2048 sc1
    ds_read_b64_tr_b16 v[232:233], v14 offset:2048
    ds_read_b64_tr_b16 v[234:235], v14 offset:3072
    ds_read_b64_tr_b16 v[236:237], v15 offset:2048
    ds_read_b64_tr_b16 v[238:239], v15 offset:3072
    s_waitcnt vmcnt(9)
    buffer_load_dwordx4 v[120:123], v21, s[36:39], 0 offen offset:3072 sc1
    s_waitcnt vmcnt(9)
    buffer_load_dwordx4 v[124:127], v20, s[36:39], 0 offen offset:3072 sc1
    ds_read_b64_tr_b16 v[240:241], v14 offset:4096
    ds_read_b64_tr_b16 v[242:243], v14 offset:5120
    ds_read_b64_tr_b16 v[244:245], v15 offset:4096
    ds_read_b64_tr_b16 v[246:247], v15 offset:5120
    s_waitcnt lgkmcnt(0)
    s_and_b64 s[84:85], s[84:85], s[86:87]
    s_and_b32 s84, s84, s85
    s_and_b32 s84, s84, 2
    s_cbranch_scc0 L_poll_5
L_pend_6:
    s_waitcnt vmcnt(9)
    buffer_load_dwordx4 v[128:131], v21, s[36:39], s16 offen offset:0 sc1
    s_waitcnt vmcnt(8)
    v_mfma_f32_32x32x16_bf16 v[80:95], v[148:151], v[96:99], 0
    ds_read_b64_tr_b16 v[248:249], v14 offset:6144
    ds_read_b64_tr_b16 v[250:251], v14 offset:7168
    v_mfma_f32_32x32x16_bf16 v[64:79], v[144:147], v[96:99], 0
    buffer_load_dwordx4 v[132:135], v20, s[36:39], s16 offen offset:0 sc1
    ds_read_b64_tr_b16 v[252:253], v15 offset:6144
    ds_read_b64_tr_b16 v[254:255], v15 offset:7168
    s_waitcnt vmcnt(8)
    v_mfma_f32_32x32x16_bf16 v[48:63], v[148:151], v[100:103], 0
    v_mfma_f32_32x32x16_bf16 v[32:47], v[144:147], v[100:103], 0
    buffer_load_dwordx4 v[136:139], v21, s[36:39], s16 offen offset:1024 sc1
    s_waitcnt vmcnt(8)
    v_mfma_f32_32x32x16_bf16 v[80:95], v[156:159], v[104:107], v[80:95]
    v_mfma_f32_32x32x16_bf16 v[64:79], v[152:155], v[104:107], v[64:79]
    buffer_load_dwordx4 v[140:143], v20, s[36:39], s16 offen offset:1024 sc1
    s_waitcnt vmcnt(8)
    v_mfma_f32_32x32x16_bf16 v[48:63], v[156:159], v[108:111], v[48:63]
    v_mfma_f32_32x32x16_bf16 v[32:47], v[152:155], v[108:111], v[32:47]
    buffer_load_dwordx4 v[96:99], v21, s[36:39], s16 offen offset:2048 sc1
    s_waitcnt vmcnt(8)
    v_mfma_f32_32x32x16_bf16 v[80:95], v[164:167], v[112:115], v[80:95]
    v_mfma_f32_32x32x16_bf16 v[64:79], v[160:163], v[112:115], v[64:79]
    buffer_load_dwordx4 v[100:103], v20, s[36:39], s16 offen offset:2048 sc1
    s_waitcnt vmcnt(8)
    v_mfma_f32_32x32x16_bf16 v[48:63], v[164:167], v[116:119], v[48:63]
    v_mfma_f32_32x32x16_bf16 v[32:47], v[160:163], v[116:119], v[32:47]
    buffer_load_dwordx4 v[104:107], v21, s[36:39], s16 offen offset:3072 sc1
    s_waitcnt vmcnt(8)
    v_mfma_f32_32x32x16_bf16 v[80:95], v[172:175], v[120:123], v[80:95]
    v_mfma_f32_32x32x16_bf16 v[64:79], v[168:171], v[120:123], v[64:79]
    buffer_load_dwordx4 v[108:111], v20, s[36:39], s16 offen offset:3072 sc1
    s_waitcnt vmcnt(8)
    v_mfma_f32_32x32x16_bf16 v[48:63], v[172:175], v[124:127], v[48:63]
    v_mfma_f32_32x32x16_bf16 v[32:47], v[168:171], v[124:127], v[32:47]
    s_addk_i32 m0, 2048
    s_add_u32 s13, s5, 0
    buffer_load_dwordx4 v12, s[40:43], s13 offen offset:0 lds
    s_waitcnt vmcnt(8)
    v_mfma_f32_32x32x16_bf16 v[80:95], v[180:183], v[128:131], v[80:95]
    v_mfma_f32_32x32x16_bf16 v[64:79], v[176:179], v[128:131], v[64:79]
    buffer_load_dwordx4 v13, s[40:43], s13 offen offset:1024 lds
    s_waitcnt vmcnt(8)
    v_mfma_f32_32x32x16_bf16 v[48:63], v[180:183], v[132:135], v[48:63]
    v_mfma_f32_32x32x16_bf16 v[32:47], v[176:179], v[132:135], v[32:47]
    s_addk_i32 m0, 2048
    s_addk_i32 s13, 14336
    buffer_load_dwordx4 v12, s[40:43], s13 offen offset:0 lds
    s_waitcnt vmcnt(8)
    v_mfma_f32_32x32x16_bf16 v[80:95], v[188:191], v[136:139], v[80:95]
    v_mfma_f32_32x32x16_bf16 v[64:79], v[184:187], v[136:139], v[64:79]
    buffer_load_dwordx4 v13, s[40:43], s13 offen offset:1024 lds
    s_waitcnt vmcnt(8)
    v_mfma_f32_32x32x16_bf16 v[48:63], v[188:191], v[140:143], v[48:63]
    v_mfma_f32_32x32x16_bf16 v[32:47], v[184:187], v[140:143], v[32:47]
    s_addk_i32 m0, 2048
    s_add_u32 s13, s76, 0
    buffer_load_dwordx4 v12, s[44:47], s13 offen offset:0 lds
    s_waitcnt vmcnt(8)
    v_mfma_f32_32x32x16_bf16 v[80:95], v[196:199], v[96:99], v[80:95]
    v_mfma_f32_32x32x16_bf16 v[64:79], v[192:195], v[96:99], v[64:79]
    buffer_load_dwordx4 v13, s[44:47], s13 offen offset:1024 lds
    s_waitcnt vmcnt(8)
    v_mfma_f32_32x32x16_bf16 v[48:63], v[196:199], v[100:103], v[48:63]
    s_load_dwordx4 s[84:87], s[14:15], 0 glc
    v_mfma_f32_32x32x16_bf16 v[32:47], v[192:195], v[100:103], v[32:47]
    s_addk_i32 m0, 2048
    s_addk_i32 s13, 14336
    buffer_load_dwordx4 v12, s[44:47], s13 offen offset:0 lds
    s_waitcnt vmcnt(8)
    v_mfma_f32_32x32x16_bf16 v[80:95], v[204:207], v[104:107], v[80:95]
    v_mfma_f32_32x32x16_bf16 v[64:79], v[200:203], v[104:107], v[64:79]
    buffer_load_dwordx4 v13, s[44:47], s13 offen offset:1024 lds
    s_waitcnt vmcnt(8)
    v_mfma_f32_32x32x16_bf16 v[48:63], v[204:207], v[108:111], v[48:63]
    v_mfma_f32_32x32x16_bf16 v[32:47], v[200:203], v[108:111], v[32:47]
    s_addk_i32 m0, 2048
    s_addk_i32 s13, 14336
    buffer_load_dwordx4 v12, s[44:47], s13 offen offset:0 lds
    buffer_load_dwordx4 v13, s[44:47], s13 offen offset:1024 lds
    s_addk_i32 m0, -16384
    s_addk_i32 s13, 14336
    s_waitcnt vmcnt(9)
    buffer_load_dwordx4 v12, s[44:47], s13 offen offset:0 lds
    s_waitcnt vmcnt(9)
    buffer_load_dwordx4 v13, s[44:47], s13 offen offset:1024 lds
    s_addk_i32 m0, 2048
    s_addk_i32 s13, 14336
    s_waitcnt vmcnt(9)
    buffer_load_dwordx4 v12, s[44:47], s13 offen offset:0 lds
    s_waitcnt vmcnt(9)
    buffer_load_dwordx4 v13, s[44:47], s13 offen offset:1024 lds
    s_waitcnt lgkmcnt(0)
    s_and_b64 s[84:85], s[84:85], s[86:87]
    s_and_b32 s84, s84, s85
    s_and_b32 s84, s84, 4
    s_cbranch_scc0 L_poll_7
L_pend_8:
    s_waitcnt vmcnt(9)
    buffer_load_dwordx4 v[112:115], v21, s[36:39], s17 offen offset:0 sc1
    s_waitcnt vmcnt(9)
    buffer_load_dwordx4 v[116:119], v21, s[36:39], s17 offen offset:1024 sc1
    s_waitcnt vmcnt(9)
    buffer_load_dwordx4 v[120:123], v21, s[36:39], s17 offen offset:2048 sc1
    s_waitcnt vmcnt(9)
    buffer_load_dwordx4 v[124:127], v21, s[36:39], s17 offen offset:3072 sc1
    s_waitcnt vmcnt(9)
    buffer_load_dwordx4 v[128:131], v20, s[36:39], s17 offen offset:0 sc1
    s_waitcnt vmcnt(9)
    buffer_load_dwordx4 v[132:135], v20, s[36:39], s17 offen offset:1024 sc1
    s_waitcnt vmcnt(9)
    buffer_load_dwordx4 v[136:139], v20, s[36:39], s17 offen offset:2048 sc1
    s_waitcnt vmcnt(9)
    buffer_load_dwordx4 v[140:143], v20, s[36:39], s17 offen offset:3072 sc1
    s_barrier
    buffer_load_dwordx4 v[96:99], v3, s[36:39], s17 offen offset:3072 sc1
    s_waitcnt vmcnt(8)
    v_mfma_f32_32x32x16_bf16 v[80:95], v[212:215], v[112:115], v[80:95]
    v_mfma_f32_32x32x16_bf16 v[64:79], v[208:211], v[112:115], v[64:79]
    buffer_load_dwordx4 v[100:103], v3, s[36:39], s17 offen offset:2048 sc1
    s_waitcnt vmcnt(8)
    v_mfma_f32_32x32x16_bf16 v[80:95], v[220:223], v[116:119], v[80:95]
    v_mfma_f32_32x32x16_bf16 v[64:79], v[216:219], v[116:119], v[64:79]
    buffer_load_dwordx4 v[104:107], v3, s[36:39], s17 offen offset:1024 sc1
    s_waitcnt vmcnt(8)
    v_mfma_f32_32x32x16_bf16 v[80:95], v[228:231], v[120:123], v[80:95]
    v_mfma_f32_32x32x16_bf16 v[64:79], v[224:227], v[120:123], v[64:79]
    buffer_load_dwordx4 v[108:111], v3, s[36:39], s17 offen offset:0 sc1
    s_waitcnt vmcnt(8)
    v_mfma_f32_32x32x16_bf16 v[80:95], v[236:239], v[124:127], v[80:95]
    v_mfma_f32_32x32x16_bf16 v[64:79], v[232:235], v[124:127], v[64:79]
    buffer_load_dwordx4 v[112:115], v2, s[36:39], s17 offen offset:3072 sc1
    s_waitcnt vmcnt(8)
    v_mfma_f32_32x32x16_bf16 v[48:63], v[212:215], v[128:131], v[48:63]
    v_mfma_f32_32x32x16_bf16 v[32:47], v[208:211], v[128:131], v[32:47]
    buffer_load_dwordx4 v[116:119], v2, s[36:39], s17 offen offset:2048 sc1
    s_waitcnt vmcnt(8)
    v_mfma_f32_32x32x16_bf16 v[48:63], v[220:223], v[132:135], v[48:63]
    s_nop 3
    ds_write_b128 v27, v[80:83] offset:13056
    v_mfma_f32_32x32x16_bf16 v[32:47], v[216:219], v[132:135], v[32:47]
    buffer_load_dwordx4 v[120:123], v2, s[36:39], s17 offen offset:1024 sc1
    ds_write_b128 v27, v[84:87] offset:14144
    s_waitcnt vmcnt(8)
    v_mfma_f32_32x32x16_bf16 v[48:63], v[228:231], v[136:139], v[48:63]
    ds_write_b128 v27, v[88:91] offset:15232
    v_mfma_f32_32x32x16_bf16 v[32:47], v[224:227], v[136:139], v[32:47]
    buffer_load_dwordx4 v[124:127], v2, s[36:39], s17 offen offset:0 sc1
    ds_write_b128 v27, v[92:95] offset:16320
    s_waitcnt vmcnt(8)
    v_mfma_f32_32x32x16_bf16 v[48:63], v[236:239], v[140:143], v[48:63]
    ds_write_b128 v26, v[64:67] offset:8704
    v_mfma_f32_32x32x16_bf16 v[32:47], v[232:235], v[140:143], v[32:47]
    buffer_load_dwordx4 v[128:131], v3, s[36:39], s16 offen offset:3072 sc1
    ds_write_b128 v26, v[68:71] offset:9792
    ds_write_b128 v26, v[72:75] offset:10880
    buffer_load_dwordx4 v[132:135], v2, s[36:39], s16 offen offset:3072 sc1
    ds_write_b128 v26, v[76:79] offset:11968
    s_waitcnt vmcnt(9) lgkmcnt(0)
    v_mfma_f32_32x32x16_bf16 v[80:95], v[236:239], v[96:99], 0
    s_nop 2
    ds_write_b128 v25, v[48:51] offset:4352
    v_mfma_f32_32x32x16_bf16 v[64:79], v[232:235], v[96:99], 0
    s_addk_i32 m0, 2048
    s_addk_i32 s13, 14336
    buffer_load_dwordx4 v12, s[44:47], s13 offen offset:0 lds
    ds_write_b128 v25, v[52:55] offset:5440
    s_waitcnt vmcnt(9)
    v_mfma_f32_32x32x16_bf16 v[80:95], v[228:231], v[100:103], v[80:95]
    ds_write_b128 v25, v[56:59] offset:6528
    v_mfma_f32_32x32x16_bf16 v[64:79], v[224:227], v[100:103], v[64:79]
    buffer_load_dwordx4 v13, s[44:47], s13 offen offset:1024 lds
    ds_write_b128 v25, v[60:63] offset:7616
    s_waitcnt vmcnt(9)
    v_mfma_f32_32x32x16_bf16 v[80:95], v[220:223], v[104:107], v[80:95]
    ds_write_b128 v24, v[32:35] offset:0
    v_mfma_f32_32x32x16_bf16 v[64:79], v[216:219], v[104:107], v[64:79]
    buffer_load_dwordx4 v[136:139], v3, s[36:39], s16 offen offset:2048 sc1
    ds_write_b128 v24, v[36:39] offset:1088
    s_waitcnt vmcnt(9)
    v_mfma_f32_32x32x16_bf16 v[80:95], v[212:215], v[108:111], v[80:95]
    ds_write_b128 v24, v[40:43] offset:2176
    v_mfma_f32_32x32x16_bf16 v[64:79], v[208:211], v[108:111], v[64:79]
    buffer_load_dwordx4 v[140:143], v2, s[36:39], s16 offen offset:2048 sc1
    ds_write_b128 v24, v[44:47] offset:3264
    s_waitcnt lgkmcnt(0)
    s_barrier
    s_waitcnt vmcnt(9)
    v_mfma_f32_32x32x16_bf16 v[48:63], v[236:239], v[112:115], 0
    s_load_dwordx4 s[84:87], s[14:15], 0 glc
    v_mfma_f32_32x32x16_bf16 v[32:47], v[232:235], v[112:115], 0
    s_addk_i32 m0, 2048
    s_addk_i32 s13, 14336
    buffer_load_dwordx4 v12, s[44:47], s13 offen offset:0 lds
    s_waitcnt vmcnt(9)
    v_mfma_f32_32x32x16_bf16 v[48:63], v[228:231], v[116:119], v[48:63]
    v_mfma_f32_32x32x16_bf16 v[32:47], v[224:227], v[116:119], v[32:47]
    buffer_load_dwordx4 v13, s[44:47], s13 offen offset:1024 lds
    ds_read_b64_tr_b16 v[224:225], v14 offset:8192
    ds_read_b64_tr_b16 v[226:227], v14 offset:9216
    s_waitcnt vmcnt(9)
    v_mfma_f32_32x32x16_bf16 v[48:63], v[220:223], v[120:123], v[48:63]
    ds_read_b64_tr_b16 v[228:229], v15 offset:8192
    ds_read_b64_tr_b16 v[230:231], v15 offset:9216
    v_mfma_f32_32x32x16_bf16 v[32:47], v[216:219], v[120:123], v[32:47]
    buffer_load_dwordx4 v[96:99], v3, s[36:39], s16 offen offset:1024 sc1
    ds_read_b64_tr_b16 v[216:217], v14 offset:10240
    ds_read_b64_tr_b16 v[218:219], v14 offset:11264
    s_waitcnt vmcnt(9)
    v_mfma_f32_32x32x16_bf16 v[48:63], v[212:215], v[124:127], v[48:63]
    ds_read_b64_tr_b16 v[220:221], v15 offset:10240
    ds_read_b64_tr_b16 v[222:223], v15 offset:11264
    v_mfma_f32_32x32x16_bf16 v[32:47], v[208:211], v[124:127], v[32:47]
    buffer_load_dwordx4 v[100:103], v2, s[36:39], s16 offen offset:1024 sc1
    ds_read_b64_tr_b16 v[208:209], v14 offset:12288
    ds_read_b64_tr_b16 v[210:211], v14 offset:13312
    s_waitcnt vmcnt(9)
    v_mfma_f32_32x32x16_bf16 v[80:95], v[204:207], v[128:131], v[80:95]
    ds_read_b64_tr_b16 v[212:213], v15 offset:12288
    ds_read_b64_tr_b16 v[214:215], v15 offset:13312
    v_mfma_f32_32x32x16_bf16 v[64:79], v[200:203], v[128:131], v[64:79]
    buffer_load_dwordx4 v[104:107], v3, s[36:39], s16 offen offset:0 sc1
    s_waitcnt vmcnt(9)
    v_mfma_f32_32x32x16_bf16 v[48:63], v[204:207], v[132:135], v[48:63]
    v_mfma_f32_32x32x16_bf16 v[32:47], v[200:203], v[132:135], v[32:47]
    buffer_load_dwordx4 v[108:111], v2, s[36:39], s16 offen offset:0 sc1
    ds_read_b64_tr_b16 v[200:201], v14 offset:14336
    ds_read_b64_tr_b16 v[202:203], v14 offset:15360
    ds_read_b64_tr_b16 v[204:205], v15 offset:14336
    ds_read_b64_tr_b16 v[206:207], v15 offset:15360
    buffer_load_dwordx4 v[112:115], v3, s[36:39], 0 offen offset:3072 sc1
    s_waitcnt vmcnt(8)
    v_mfma_f32_32x32x16_bf16 v[80:95], v[196:199], v[136:139], v[80:95]
    v_mfma_f32_32x32x16_bf16 v[64:79], v[192:195], v[136:139], v[64:79]
    buffer_load_dwordx4 v[116:119], v2, s[36:39], 0 offen offset:3072 sc1
    s_waitcnt vmcnt(8)
    v_mfma_f32_32x32x16_bf16 v[48:63], v[196:199], v[140:143], v[48:63]
    v_mfma_f32_32x32x16_bf16 v[32:47], v[192:195], v[140:143], v[32:47]
    ds_read_b64_tr_b16 v[192:193], v14 offset:16384
    ds_read_b64_tr_b16 v[194:195], v14 offset:17408
    s_waitcnt vmcnt(5)
    v_mfma_f32_32x32x16_bf16 v[80:95], v[188:191], v[96:99], v[80:95]
    ds_read_b64_tr_b16 v[196:197], v15 offset:16384
    ds_read_b64_tr_b16 v[198:199], v15 offset:17408
    v_mfma_f32_32x32x16_bf16 v[64:79], v[184:187], v[96:99], v[64:79]
    s_waitcnt vmcnt(4)
    v_mfma_f32_32x32x16_bf16 v[48:63], v[188:191], v[100:103], v[48:63]
    v_mfma_f32_32x32x16_bf16 v[32:47], v[184:187], v[100:103], v[32:47]
    ds_read_b64_tr_b16 v[184:185], v14 offset:0
    ds_read_b64_tr_b16 v[186:187], v14 offset:1024
    s_waitcnt lgkmcnt(0)
    s_and_b64 s[84:85], s[84:85], s[86:87]
    s_and_b32 s84, s84, s85
    s_and_b32 s84, s84, 8
    s_cbranch_scc0 L_poll_9
L_pend_10:
    s_load_dwordx4 s[84:87], s[92:93], 0 glc
    buffer_load_dwordx4 v[120:123], v3, s[36:39], 0 offen offset:2048 sc1
    ds_read_b64_tr_b16 v[188:189], v15 offset:0
    ds_read_b64_tr_b16 v[190:191], v15 offset:1024
    buffer_load_dwordx4 v[124:127], v2, s[36:39], 0 offen offset:2048 sc1
    buffer_load_dwordx4 v[128:131], v3, s[36:39], 0 offen offset:1024 sc1
    buffer_load_dwordx4 v[132:135], v2, s[36:39], 0 offen offset:1024 sc1
    buffer_load_dwordx4 v[136:139], v3, s[36:39], 0 offen offset:0 sc1
    s_waitcnt vmcnt(8)
    v_mfma_f32_32x32x16_bf16 v[80:95], v[180:183], v[104:107], v[80:95]
    v_mfma_f32_32x32x16_bf16 v[64:79], v[176:179], v[104:107], v[64:79]
    buffer_load_dwordx4 v[140:143], v2, s[36:39], 0 offen offset:0 sc1
    s_waitcnt vmcnt(8)
    v_mfma_f32_32x32x16_bf16 v[48:63], v[180:183], v[108:111], v[48:63]
    s_waitcnt lgkmcnt(0)
    s_and_b64 s[84:85], s[84:85], s[86:87]
    s_and_b32 s84, s84, s85
    s_and_b32 s84, s84, 8
    s_cbranch_scc0 L_poll_11
L_pend_12:
    s_load_dwordx2 s[84:85], s[14:15], 16 glc
    v_mfma_f32_32x32x16_bf16 v[32:47], v[176:179], v[108:111], v[32:47]
    buffer_load_dwordx4 v[96:99], v3, s[36:39], s18 offen offset:0 sc1
    ds_read_b64_tr_b16 v[176:177], v14 offset:2048
    ds_read_b64_tr_b16 v[178:179], v14 offset:3072
    s_waitcnt vmcnt(8)
    v_mfma_f32_32x32x16_bf16 v[80:95], v[172:175], v[112:115], v[80:95]
    ds_read_b64_tr_b16 v[180:181], v15 offset:2048
    ds_read_b64_tr_b16 v[182:183], v15 offset:3072
    v_mfma_f32_32x32x16_bf16 v[64:79], v[168:171], v[112:115], v[64:79]
    buffer_load_dwordx4 v[100:103], v2, s[36:39], s18 offen offset:0 sc1
    s_waitcnt vmcnt(8)
    v_mfma_f32_32x32x16_bf16 v[48:63], v[172:175], v[116:119], v[48:63]
    v_mfma_f32_32x32x16_bf16 v[32:47], v[168:171], v[116:119], v[32:47]
    buffer_load_dwordx4 v[104:107], v3, s[36:39], s18 offen offset:1024 sc1
    ds_read_b64_tr_b16 v[168:169], v14 offset:4096
    ds_read_b64_tr_b16 v[170:171], v14 offset:5120
    s_waitcnt vmcnt(8)
    v_mfma_f32_32x32x16_bf16 v[80:95], v[164:167], v[120:123], v[80:95]
    ds_read_b64_tr_b16 v[172:173], v15 offset:4096
    ds_read_b64_tr_b16 v[174:175], v15 offset:5120
    v_mfma_f32_32x32x16_bf16 v[64:79], v[160:163], v[120:123], v[64:79]
    buffer_load_dwordx4 v[108:111], v2, s[36:39], s18 offen offset:1024 sc1
    s_waitcnt vmcnt(8)
    v_mfma_f32_32x32x16_bf16 v[48:63], v[164:167], v[124:127], v[48:63]
    v_mfma_f32_32x32x16_bf16 v[32:47], v[160:163], v[124:127], v[32:47]
    buffer_load_dwordx4 v[112:115], v3, s[36:39], s95 offen offset:0 sc1
    ds_read_b64_tr_b16 v[160:161], v14 offset:6144
    ds_read_b64_tr_b16 v[162:163], v14 offset:7168
    s_waitcnt vmcnt(8)
    v_mfma_f32_32x32x16_bf16 v[80:95], v[156:159], v[128:131], v[80:95]
    ds_read_b64_tr_b16 v[164:165], v15 offset:6144
    ds_read_b64_tr_b16 v[166:167], v15 offset:7168
    v_mfma_f32_32x32x16_bf16 v[64:79], v[152:155], v[128:131], v[64:79]
    buffer_load_dwordx4 v[116:119], v2, s[36:39], s95 offen offset:0 sc1
    s_waitcnt vmcnt(8)
    v_mfma_f32_32x32x16_bf16 v[48:63], v[156:159], v[132:135], v[48:63]
    v_mfma_f32_32x32x16_bf16 v[32:47], v[152:155], v[132:135], v[32:47]
    buffer_load_dwordx4 v[120:123], v3, s[36:39], s95 offen offset:1024 sc1
    s_waitcnt vmcnt(8)
    v_mfma_f32_32x32x16_bf16 v[80:95], v[148:151], v[136:139], v[80:95]
    v_mfma_f32_32x32x16_bf16 v[64:79], v[144:147], v[136:139], v[64:79]
    buffer_load_dwordx4 v[124:127], v2, s[36:39], s95 offen offset:1024 sc1
    s_waitcnt vmcnt(8)
    v_mfma_f32_32x32x16_bf16 v[48:63], v[148:151], v[140:143], v[48:63]
    s_waitcnt lgkmcnt(0)
    s_and_b32 s84, s84, s85
    s_and_b32 s84, s84, 1
    s_cbranch_scc0 L_poll_13
L_pend_14:
    v_mfma_f32_32x32x16_bf16 v[32:47], v[144:147], v[140:143], v[32:47]
    buffer_load_dwordx4 v[128:131], v3, s[36:39], s19 offen offset:0 sc1
    s_waitcnt vmcnt(8)
    v_mfma_f32_32x32x16_bf16 v[80:95], v[244:247], v[96:99], v[80:95]
    v_mfma_f32_32x32x16_bf16 v[64:79], v[240:243], v[96:99], v[64:79]
    buffer_load_dwordx4 v[132:135], v3, s[36:39], s19 offen offset:1024 sc1
    s_waitcnt vmcnt(8)
    v_mfma_f32_32x32x16_bf16 v[48:63], v[244:247], v[100:103], v[48:63]
    v_mfma_f32_32x32x16_bf16 v[32:47], v[240:243], v[100:103], v[32:47]
    buffer_load_dwordx4 v[136:139], v3, s[36:39], s19 offen offset:2048 sc1
    s_waitcnt vmcnt(8)
    v_mfma_f32_32x32x16_bf16 v[80:95], v[252:255], v[104:107], v[80:95]
    v_mfma_f32_32x32x16_bf16 v[64:79], v[248:251], v[104:107], v[64:79]
    buffer_load_dwordx4 v[140:143], v3, s[36:39], s19 offen offset:3072 sc1
    s_waitcnt vmcnt(8)
    v_mfma_f32_32x32x16_bf16 v[48:63], v[252:255], v[108:111], v[48:63]
    v_mfma_f32_32x32x16_bf16 v[32:47], v[248:251], v[108:111], v[32:47]
    buffer_load_dwordx4 v[96:99], v3, s[36:39], s20 offen offset:0 sc1
    s_waitcnt vmcnt(8)
    v_mfma_f32_32x32x16_bf16 v[80:95], v[228:231], v[112:115], v[80:95]
    v_mfma_f32_32x32x16_bf16 v[64:79], v[224:227], v[112:115], v[64:79]
    buffer_load_dwordx4 v[100:103], v3, s[36:39], s20 offen offset:1024 sc1
    s_waitcnt vmcnt(8)
    v_mfma_f32_32x32x16_bf16 v[48:63], v[228:231], v[116:119], v[48:63]
    s_load_dword s84, s[14:15], s22 glc
    v_mfma_f32_32x32x16_bf16 v[32:47], v[224:227], v[116:119], v[32:47]
    buffer_load_dwordx4 v[104:107], v3, s[36:39], s20 offen offset:2048 sc1
    s_waitcnt vmcnt(8)
    v_mfma_f32_32x32x16_bf16 v[80:95], v[220:223], v[120:123], v[80:95]
    v_mfma_f32_32x32x16_bf16 v[64:79], v[216:219], v[120:123], v[64:79]
    buffer_load_dwordx4 v[108:111], v2, s[36:39], s19 offen offset:0 sc1
    s_waitcnt vmcnt(8)
    v_mfma_f32_32x32x16_bf16 v[48:63], v[220:223], v[124:127], v[48:63]
    v_mfma_f32_32x32x16_bf16 v[32:47], v[216:219], v[124:127], v[32:47]
    buffer_load_dwordx4 v[112:115], v2, s[36:39], s19 offen offset:1024 sc1
    s_waitcnt vmcnt(8)
    v_mfma_f32_32x32x16_bf16 v[80:95], v[212:215], v[128:131], v[80:95]
    v_mfma_f32_32x32x16_bf16 v[64:79], v[208:211], v[128:131], v[64:79]
    buffer_load_dwordx4 v[116:119], v2, s[36:39], s19 offen offset:2048 sc1
    s_waitcnt vmcnt(8)
    v_mfma_f32_32x32x16_bf16 v[80:95], v[204:207], v[132:135], v[80:95]
    v_mfma_f32_32x32x16_bf16 v[64:79], v[200:203], v[132:135], v[64:79]
    buffer_load_dwordx4 v[120:123], v2, s[36:39], s19 offen offset:3072 sc1
    s_waitcnt vmcnt(8)
    v_mfma_f32_32x32x16_bf16 v[80:95], v[196:199], v[136:139], v[80:95]
    v_mfma_f32_32x32x16_bf16 v[64:79], v[192:195], v[136:139], v[64:79]
    buffer_load_dwordx4 v[124:127], v2, s[36:39], s20 offen offset:0 sc1
    s_waitcnt vmcnt(8)
    v_mfma_f32_32x32x16_bf16 v[80:95], v[188:191], v[140:143], v[80:95]
    v_mfma_f32_32x32x16_bf16 v[64:79], v[184:187], v[140:143], v[64:79]
    buffer_load_dwordx4 v[128:131], v2, s[36:39], s20 offen offset:1024 sc1
    s_waitcnt vmcnt(8)
    v_mfma_f32_32x32x16_bf16 v[80:95], v[180:183], v[96:99], v[80:95]
    v_mfma_f32_32x32x16_bf16 v[64:79], v[176:179], v[96:99], v[64:79]
    buffer_load_dwordx4 v[132:135], v2, s[36:39], s20 offen offset:2048 sc1
    s_waitcnt vmcnt(8)
    v_mfma_f32_32x32x16_bf16 v[80:95], v[172:175], v[100:103], v[80:95]
    s_waitcnt lgkmcnt(0)
    s_and_b32 s84, s84, 1
    s_cbranch_scc0 L_poll_15
L_pend_16:
    v_mfma_f32_32x32x16_bf16 v[64:79], v[168:171], v[100:103], v[64:79]
    buffer_load_dwordx4 v[248:251], v18, s[36:39], s21 offen offset:0 sc1
    buffer_load_dwordx4 v[252:255], v18, s[36:39], s21 offen offset:1024 sc1
    s_waitcnt vmcnt(9)
    v_mfma_f32_32x32x16_bf16 v[80:95], v[164:167], v[104:107], v[80:95]
    s_barrier
    v_mfma_f32_32x32x16_bf16 v[64:79], v[160:163], v[104:107], v[64:79]
    s_waitcnt vmcnt(8)
    v_mfma_f32_32x32x16_bf16 v[48:63], v[212:215], v[108:111], v[48:63]
    v_mfma_f32_32x32x16_bf16 v[32:47], v[208:211], v[108:111], v[32:47]
    s_waitcnt vmcnt(7)
    v_mfma_f32_32x32x16_bf16 v[48:63], v[204:207], v[112:115], v[48:63]
    s_nop 4
    ds_write_b128 v27, v[80:83] offset:13056
    v_mfma_f32_32x32x16_bf16 v[32:47], v[200:203], v[112:115], v[32:47]
    ds_write_b128 v27, v[84:87] offset:14144
    s_waitcnt vmcnt(6)
    v_mfma_f32_32x32x16_bf16 v[48:63], v[196:199], v[116:119], v[48:63]
    ds_write_b128 v27, v[88:91] offset:15232
    v_mfma_f32_32x32x16_bf16 v[32:47], v[192:195], v[116:119], v[32:47]
    ds_write_b128 v27, v[92:95] offset:16320
    s_waitcnt vmcnt(5)
    v_mfma_f32_32x32x16_bf16 v[48:63], v[188:191], v[120:123], v[48:63]
    ds_write_b128 v26, v[64:67] offset:8704
    v_mfma_f32_32x32x16_bf16 v[32:47], v[184:187], v[120:123], v[32:47]
    ds_write_b128 v26, v[68:71] offset:9792
    s_waitcnt vmcnt(4)
    v_mfma_f32_32x32x16_bf16 v[48:63], v[180:183], v[124:127], v[48:63]
    ds_write_b128 v26, v[72:75] offset:10880
    v_mfma_f32_32x32x16_bf16 v[32:47], v[176:179], v[124:127], v[32:47]
    ds_write_b128 v26, v[76:79] offset:11968
    s_waitcnt vmcnt(3)
    v_mfma_f32_32x32x16_bf16 v[48:63], v[172:175], v[128:131], v[48:63]
    v_mfma_f32_32x32x16_bf16 v[32:47], v[168:171], v[128:131], v[32:47]
    s_waitcnt vmcnt(2)
    v_mfma_f32_32x32x16_bf16 v[48:63], v[164:167], v[132:135], v[48:63]
    v_mfma_f32_32x32x16_bf16 v[32:47], v[160:163], v[132:135], v[32:47]
    s_waitcnt vmcnt(0)
    v_lshlrev_b32 v232, 16, v248
    v_and_b32 v233, s10, v248
    v_lshlrev_b32 v234, 16, v249
    v_and_b32 v235, s10, v249
    v_lshlrev_b32 v236, 16, v250
    v_and_b32 v237, s10, v250
    v_lshlrev_b32 v238, 16, v251
    v_and_b32 v239, s10, v251
    v_lshlrev_b32 v240, 16, v252
    v_and_b32 v241, s10, v252
    ds_write_b128 v25, v[48:51] offset:4352
    v_lshlrev_b32 v242, 16, v253
    v_and_b32 v243, s10, v253
    v_lshlrev_b32 v244, 16, v254
    v_and_b32 v245, s10, v254
    v_lshlrev_b32 v246, 16, v255
    ds_write_b128 v25, v[52:55] offset:5440
    v_and_b32 v247, s10, v255
    ds_write_b128 v25, v[56:59] offset:6528
    ds_write_b128 v25, v[60:63] offset:7616
    ds_write_b128 v24, v[32:35] offset:0
    ds_write_b128 v24, v[36:39] offset:1088
    ds_write_b128 v24, v[40:43] offset:2176
    ds_write_b128 v24, v[44:47] offset:3264
    s_waitcnt lgkmcnt(0)
    s_barrier
    ds_read_b128 v[32:35], v17 offset:0
    ds_read_b128 v[48:51], v17 offset:4352
    ds_read_b128 v[64:67], v17 offset:8704
    ds_read_b128 v[80:83], v17 offset:13056
    ds_read_b128 v[36:39], v17 offset:512
    ds_read_b128 v[52:55], v17 offset:4864
    ds_read_b128 v[68:71], v17 offset:9216
    ds_read_b128 v[84:87], v17 offset:13568
    ds_read_b128 v[40:43], v17 offset:256
    ds_read_b128 v[56:59], v17 offset:4608
    ds_read_b128 v[72:75], v17 offset:8960
    ds_read_b128 v[88:91], v17 offset:13312
    ds_read_b128 v[44:47], v17 offset:768
    ds_read_b128 v[60:63], v17 offset:5120
    ds_read_b128 v[76:79], v17 offset:9472
    ds_read_b128 v[92:95], v17 offset:13824
    s_waitcnt lgkmcnt(12)
    v_pk_add_f32 v[32:33], v[32:33], v[48:49]
    v_pk_add_f32 v[64:65], v[64:65], v[80:81]
    v_pk_add_f32 v[32:33], v[32:33], v[232:233]
    v_pk_add_f32 v[34:35], v[34:35], v[50:51]
    v_pk_add_f32 v[66:67], v[66:67], v[82:83]
    v_pk_add_f32 v[34:35], v[34:35], v[234:235]
    v_pk_add_f32 v[32:33], v[32:33], v[64:65]
    v_pk_add_f32 v[34:35], v[34:35], v[66:67]
    v_cvt_pk_bf16_f32 v96, v32, v33
    v_cvt_pk_bf16_f32 v97, v34, v35
    s_waitcnt lgkmcnt(8)
    v_pk_add_f32 v[36:37], v[36:37], v[52:53]
    v_pk_add_f32 v[68:69], v[68:69], v[84:85]
    v_pk_add_f32 v[36:37], v[36:37], v[236:237]
    v_pk_add_f32 v[38:39], v[38:39], v[54:55]
    v_pk_add_f32 v[70:71], v[70:71], v[86:87]
    v_pk_add_f32 v[38:39], v[38:39], v[238:239]
    v_pk_add_f32 v[36:37], v[36:37], v[68:69]
    v_pk_add_f32 v[38:39], v[38:39], v[70:71]
    v_cvt_pk_bf16_f32 v98, v36, v37
    v_cvt_pk_bf16_f32 v99, v38, v39
    buffer_store_dwordx4 v[96:99], v4, s[48:51], s61 offen
    s_waitcnt lgkmcnt(4)
    v_pk_add_f32 v[40:41], v[40:41], v[56:57]
    v_pk_add_f32 v[72:73], v[72:73], v[88:89]
    v_pk_add_f32 v[40:41], v[40:41], v[240:241]
    v_pk_add_f32 v[42:43], v[42:43], v[58:59]
    v_pk_add_f32 v[74:75], v[74:75], v[90:91]
    v_pk_add_f32 v[42:43], v[42:43], v[242:243]
    v_pk_add_f32 v[40:41], v[40:41], v[72:73]
    v_pk_add_f32 v[42:43], v[42:43], v[74:75]
    v_cvt_pk_bf16_f32 v100, v40, v41
    v_cvt_pk_bf16_f32 v101, v42, v43
    s_waitcnt lgkmcnt(0)
    v_pk_add_f32 v[44:45], v[44:45], v[60:61]
    v_pk_add_f32 v[76:77], v[76:77], v[92:93]
    v_pk_add_f32 v[44:45], v[44:45], v[244:245]
    v_pk_add_f32 v[46:47], v[46:47], v[62:63]
    v_pk_add_f32 v[78:79], v[78:79], v[94:95]
    v_pk_add_f32 v[46:47], v[46:47], v[246:247]
    v_pk_add_f32 v[44:45], v[44:45], v[76:77]
    v_pk_add_f32 v[46:47], v[46:47], v[78:79]
    v_cvt_pk_bf16_f32 v102, v44, v45
    v_cvt_pk_bf16_f32 v103, v46, v47
    buffer_store_dwordx4 v[100:103], v4, s[48:51], s79 offen
    s_endpgm
L_Bk:
    s_barrier
    s_add_u32 m0, s26, 28672
    s_add_u32 s27, s62, s91
    buffer_load_dwordx4 v8, s[32:35], s27 offen offset:0 lds
    buffer_load_dwordx4 v9, s[32:35], s27 offen offset:1024 lds
    s_addk_i32 m0, 2048
    s_add_u32 s27, s62, s92
    buffer_load_dwordx4 v8, s[32:35], s27 offen offset:0 lds
    buffer_load_dwordx4 v9, s[32:35], s27 offen offset:1024 lds
    s_addk_i32 m0, 2048
    s_add_u32 s27, s62, s93
    buffer_load_dwordx4 v8, s[32:35], s27 offen offset:0 lds
    buffer_load_dwordx4 v9, s[32:35], s27 offen offset:1024 lds
    s_addk_i32 m0, 2048
    s_add_u32 s27, s62, s94
    buffer_load_dwordx4 v8, s[32:35], s27 offen offset:0 lds
    buffer_load_dwordx4 v9, s[32:35], s27 offen offset:1024 lds
    s_addk_i32 m0, 2048
    s_add_u32 s27, s62, s95
    buffer_load_dwordx4 v8, s[32:35], s27 offen offset:0 lds
    s_waitcnt vmcnt(7)
    s_barrier
    buffer_load_dwordx4 v9, s[32:35], s27 offen offset:1024 lds
    s_addk_i32 m0, 2048
    s_add_u32 s27, s62, s96
    buffer_load_dwordx4 v8, s[32:35], s27 offen offset:0 lds
    s_waitcnt vmcnt(7)
    s_barrier
    buffer_load_dwordx4 v9, s[32:35], s27 offen offset:1024 lds
    s_add_u32 m0, s26, 0
    s_add_u32 s27, s62, s97
    buffer_load_dwordx4 v8, s[32:35], s27 offen offset:0 lds
    s_waitcnt vmcnt(7)
    s_barrier
    buffer_load_dwordx4 v9, s[32:35], s27 offen offset:1024 lds
    s_addk_i32 m0, 2048
    s_add_u32 s27, s63, s91
    buffer_load_dwordx4 v8, s[32:35], s27 offen offset:0 lds
    s_waitcnt vmcnt(7)
    s_barrier
    buffer_load_dwordx4 v9, s[32:35], s27 offen offset:1024 lds
    s_addk_i32 m0, 2048
    s_add_u32 s27, s63, s92
    buffer_load_dwordx4 v8, s[32:35], s27 offen offset:0 lds
    s_waitcnt vmcnt(7)
    s_barrier
    buffer_load_dwordx4 v9, s[32:35], s27 offen offset:1024 lds
    s_addk_i32 m0, 2048
    s_add_u32 s27, s63, s93
    buffer_load_dwordx4 v8, s[32:35], s27 offen offset:0 lds
    s_waitcnt vmcnt(7)
    s_barrier
    buffer_load_dwordx4 v9, s[32:35], s27 offen offset:1024 lds
    s_addk_i32 m0, 2048
    s_add_u32 s27, s63, s94
    buffer_load_dwordx4 v8, s[32:35], s27 offen offset:0 lds
    s_waitcnt vmcnt(7)
    s_barrier
    buffer_load_dwordx4 v9, s[32:35], s27 offen offset:1024 lds
    s_addk_i32 m0, 2048
    s_add_u32 s27, s63, s95
    buffer_load_dwordx4 v8, s[32:35], s27 offen offset:0 lds
    s_waitcnt vmcnt(7)
    s_barrier
    s_waitcnt vmcnt(4)
    buffer_load_dwordx4 v9, s[32:35], s27 offen offset:1024 lds
    s_addk_i32 m0, 2048
    s_add_u32 s27, s63, s96
    s_waitcnt vmcnt(4)
    buffer_load_dwordx4 v8, s[32:35], s27 offen offset:0 lds
    s_barrier
    s_waitcnt vmcnt(4)
    buffer_load_dwordx4 v9, s[32:35], s27 offen offset:1024 lds
    s_addk_i32 m0, 2048
    s_add_u32 s27, s63, s97
    s_waitcnt vmcnt(4)
    buffer_load_dwordx4 v8, s[32:35], s27 offen offset:0 lds
    s_waitcnt vmcnt(4)
    buffer_load_dwordx4 v9, s[32:35], s27 offen offset:1024 lds
    s_barrier
    s_addk_i32 m0, 2048
    s_add_u32 s27, s64, s91
    s_waitcnt vmcnt(4)
    buffer_load_dwordx4 v10, s[32:35], s27 offen offset:0 lds
    buffer_load_dwordx4 v11, s[32:35], s27 offen offset:1024 lds
    s_addk_i32 m0, 2048
    s_add_u32 s27, s64, s92
    s_waitcnt vmcnt(5)
    buffer_load_dwordx4 v10, s[32:35], s27 offen offset:0 lds
    s_barrier
    buffer_load_dwordx4 v11, s[32:35], s27 offen offset:1024 lds
    s_addk_i32 m0, 2048
    s_add_u32 s27, s64, s93
    s_waitcnt vmcnt(6)
    buffer_load_dwordx4 v10, s[32:35], s27 offen offset:0 lds
    buffer_load_dwordx4 v11, s[32:35], s27 offen offset:1024 lds
    s_barrier
    s_addk_i32 m0, 2048
    s_add_u32 s27, s64, s94
    s_waitcnt vmcnt(7)
    buffer_load_dwordx4 v10, s[32:35], s27 offen offset:0 lds
    buffer_load_dwordx4 v11, s[32:35], s27 offen offset:1024 lds
    s_addk_i32 m0, 2048
    s_add_u32 s27, s64, s95
    s_waitcnt vmcnt(8)
    buffer_load_dwordx4 v10, s[32:35], s27 offen offset:0 lds
    buffer_load_dwordx4 v11, s[32:35], s27 offen offset:1024 lds
    s_barrier
    s_addk_i32 m0, 2048
    s_add_u32 s27, s64, s96
    s_waitcnt vmcnt(9)
    buffer_load_dwordx4 v10, s[32:35], s27 offen offset:0 lds
    s_waitcnt vmcnt(9)
    buffer_load_dwordx4 v11, s[32:35], s27 offen offset:1024 lds
    s_addk_i32 m0, 10240
    s_add_u32 s27, s64, s97
    s_waitcnt vmcnt(9)
    buffer_load_dwordx4 v10, s[32:35], s27 offen offset:0 lds
    s_barrier
    s_waitcnt vmcnt(9)
    buffer_load_dwordx4 v11, s[32:35], s27 offen offset:1024 lds
    s_barrier
    s_waitcnt vmcnt(0)
    s_barrier
    s_barrier
    s_setprio 3
    s_lshl_b32 s70, s3, 11
    s_add_u32 s70, s70, 28672
    v_add_u32 v64, s70, v18
    v_add_u32 v65, 81920, v64
    ds_read_b128 v[32:35], v64 offset:0
    ds_read_b128 v[36:39], v64 offset:1024
    ds_read_b128 v[40:43], v64 offset:40960
    ds_read_b128 v[44:47], v64 offset:41984
    ds_read_b128 v[48:51], v65 offset:0
    ds_read_b128 v[52:55], v65 offset:1024
    ds_read_b128 v[56:59], v65 offset:40960
    ds_read_b128 v[60:63], v65 offset:41984
    s_lshl2_add_u32 s70, s66, s3
    s_lshl4_add_u32 s70, s70, s65
    s_lshl_b32 s70, s70, 10
    s_add_u32 s70, s70, 11534336
    s_lshr_b32 s57, s3, 1
    s_lshl1_add_u32 s57, s66, s57
    s_lshl4_add_u32 s57, s57, s65
    s_lshl_b32 s57, s57, 1
    s_and_b32 s71, s3, 1
    s_add_u32 s57, s57, s71
    s_mul_i32 s57, s57, 64
    s_add_u32 s57, s57, 12091392
    v_mov_b32 v16, 1
    s_waitcnt lgkmcnt(4)
    v_add_f32 v32, v32, v40
    v_add_f32 v33, v33, v41
    v_add_f32 v34, v34, v42
    v_add_f32 v35, v35, v43
    v_add_f32 v36, v36, v44
    v_add_f32 v37, v37, v45
    v_add_f32 v38, v38, v46
    v_add_f32 v39, v39, v47
    s_waitcnt lgkmcnt(0)
    v_add_f32 v48, v48, v56
    v_add_f32 v49, v49, v57
    v_add_f32 v50, v50, v58
    v_add_f32 v51, v51, v59
    v_add_f32 v52, v52, v60
    v_add_f32 v53, v53, v61
    v_add_f32 v54, v54, v62
    v_add_f32 v55, v55, v63
    v_add_f32 v32, v32, v48
    v_add_f32 v33, v33, v49
    v_cvt_pk_bf16_f32 v32, v32, v33
    v_add_f32 v34, v34, v50
    v_add_f32 v35, v35, v51
    v_cvt_pk_bf16_f32 v33, v34, v35
    v_add_f32 v36, v36, v52
    v_add_f32 v37, v37, v53
    v_cvt_pk_bf16_f32 v34, v36, v37
    v_add_f32 v38, v38, v54
    v_add_f32 v39, v39, v55
    v_cvt_pk_bf16_f32 v35, v38, v39
    buffer_store_dwordx4 v[32:35], v18, s[36:39], s70 offen sc1
    s_setprio 0
    s_cmp_ge_u32 s68, 7
    s_cbranch_scc1 L_red
    s_lshl2_add_u32 s70, s69, s3
    s_lshl_b32 s70, s70, 7
    s_add_u32 s70, s70, 12058624
    s_add_u32 s14, s24, s70
    s_addc_u32 s15, s25, 0
    s_xor_b32 s70, s70, 512
    s_add_u32 s92, s24, s70
    s_addc_u32 s93, s25, 0
    s_sub_u32 s94, s6, s11
    s_lshl_b32 s95, s94, 11
    s_add_u32 s95, s95, s18
    s_lshl_b32 s94, s94, 12
    s_add_u32 s94, s94, s17
    s_addk_i32 m0, 2048
    s_add_u32 s13, s12, 0
    buffer_load_dwordx4 v12, s[40:43], s13 offen offset:0 lds
    buffer_load_dwordx4 v13, s[40:43], s13 offen offset:1024 lds
    s_add_u32 m0, s26, 0
    s_addk_i32 s13, 14336
    buffer_load_dwordx4 v12, s[40:43], s13 offen offset:0 lds
    buffer_load_dwordx4 v13, s[40:43], s13 offen offset:1024 lds
    s_addk_i32 m0, 2048
    s_addk_i32 s13, 14336
    buffer_load_dwordx4 v12, s[40:43], s13 offen offset:0 lds
    buffer_load_dwordx4 v13, s[40:43], s13 offen offset:1024 lds
    s_waitcnt vmcnt(6)
    buffer_store_dword v16, off, s[36:39], s57 sc1
    s_addk_i32 m0, 2048
    s_addk_i32 s13, 14336
    buffer_load_dwordx4 v12, s[40:43], s13 offen offset:0 lds
    buffer_load_dwordx4 v13, s[40:43], s13 offen offset:1024 lds
    s_addk_i32 m0, 2048
    s_add_u32 s13, s12, 458752
    buffer_load_dwordx4 v12, s[40:43], s13 offen offset:0 lds
    s_waitcnt vmcnt(9)
    buffer_load_dwordx4 v13, s[40:43], s13 offen offset:1024 lds
    s_addk_i32 m0, 2048
    s_addk_i32 s13, 14336
    s_waitcnt vmcnt(9)
    buffer_load_dwordx4 v12, s[40:43], s13 offen offset:0 lds
    ds_read_b64_tr_b16 v[144:145], v14 offset:38912
    ds_read_b64_tr_b16 v[146:147], v14 offset:39936
    ds_read_b64_tr_b16 v[148:149], v15 offset:38912
    ds_read_b64_tr_b16 v[150:151], v15 offset:39936
    s_waitcnt vmcnt(9)
    buffer_load_dwordx4 v13, s[40:43], s13 offen offset:1024 lds
    s_addk_i32 m0, 2048
    s_addk_i32 s13, 14336
    s_waitcnt vmcnt(9)
    buffer_load_dwordx4 v12, s[40:43], s13 offen offset:0 lds
    ds_read_b64_tr_b16 v[152:153], v14 offset:0
    ds_read_b64_tr_b16 v[154:155], v14 offset:1024
    ds_read_b64_tr_b16 v[156:157], v15 offset:0
    ds_read_b64_tr_b16 v[158:159], v15 offset:1024
    s_waitcnt vmcnt(9)
    buffer_load_dwordx4 v13, s[40:43], s13 offen offset:1024 lds
    s_addk_i32 m0, 2048
    s_addk_i32 s13, 14336
    s_waitcnt vmcnt(9)
    buffer_load_dwordx4 v12, s[40:43], s13 offen offset:0 lds
    ds_read_b64_tr_b16 v[160:161], v14 offset:2048
    ds_read_b64_tr_b16 v[162:163], v14 offset:3072
    ds_read_b64_tr_b16 v[164:165], v15 offset:2048
    ds_read_b64_tr_b16 v[166:167], v15 offset:3072
    s_waitcnt vmcnt(9)
    buffer_load_dwordx4 v13, s[40:43], s13 offen offset:1024 lds
    s_addk_i32 m0, 2048
    s_add_u32 s13, s12, 917504
    s_waitcnt vmcnt(9)
    buffer_load_dwordx4 v12, s[40:43], s13 offen offset:0 lds
    s_waitcnt vmcnt(9)
    buffer_load_dwordx4 v13, s[40:43], s13 offen offset:1024 lds
    ds_read_b64_tr_b16 v[168:169], v14 offset:4096
    ds_read_b64_tr_b16 v[170:171], v14 offset:5120
    ds_read_b64_tr_b16 v[172:173], v15 offset:4096
    ds_read_b64_tr_b16 v[174:175], v15 offset:5120
    s_waitcnt lgkmcnt(12)
    s_waitcnt lgkmcnt(8)
    s_addk_i32 m0, -14336
    s_addk_i32 s13, 14336
    s_waitcnt vmcnt(9)
    buffer_load_dwordx4 v12, s[40:43], s13 offen offset:0 lds
    s_waitcnt vmcnt(9)
    buffer_load_dwordx4 v13, s[40:43], s13 offen offset:1024 lds
    ds_read_b64_tr_b16 v[176:177], v14 offset:6144
    ds_read_b64_tr_b16 v[178:179], v14 offset:7168
    ds_read_b64_tr_b16 v[180:181], v15 offset:6144
    ds_read_b64_tr_b16 v[182:183], v15 offset:7168
    s_load_dwordx4 s[84:87], s[14:15], 0 glc
    s_waitcnt lgkmcnt(8)
    s_addk_i32 m0, 2048
    s_addk_i32 s13, 14336
    s_waitcnt vmcnt(9)
    buffer_load_dwordx4 v12, s[40:43], s13 offen offset:0 lds
    s_waitcnt vmcnt(9)
    buffer_load_dwordx4 v13, s[40:43], s13 offen offset:1024 lds
    ds_read_b64_tr_b16 v[184:185], v14 offset:8192
    ds_read_b64_tr_b16 v[186:187], v14 offset:9216
    ds_read_b64_tr_b16 v[188:189], v15 offset:8192
    ds_read_b64_tr_b16 v[190:191], v15 offset:9216
    s_waitcnt lgkmcnt(8)
    s_addk_i32 m0, 2048
    s_addk_i32 s13, 14336
    s_waitcnt vmcnt(9)
    buffer_load_dwordx4 v12, s[40:43], s13 offen offset:0 lds
    s_waitcnt vmcnt(9)
    buffer_load_dwordx4 v13, s[40:43], s13 offen offset:1024 lds
    ds_read_b64_tr_b16 v[192:193], v14 offset:10240
    ds_read_b64_tr_b16 v[194:195], v14 offset:11264
    ds_read_b64_tr_b16 v[196:197], v15 offset:10240
    ds_read_b64_tr_b16 v[198:199], v15 offset:11264
    s_waitcnt lgkmcnt(8)
    s_addk_i32 m0, 2048
    s_add_u32 s13, s7, 0
    s_waitcnt vmcnt(9)
    buffer_load_dwordx4 v12, s[40:43], s13 offen offset:0 lds
    s_waitcnt vmcnt(9)
    buffer_load_dwordx4 v13, s[40:43], s13 offen offset:1024 lds
    ds_read_b64_tr_b16 v[200:201], v14 offset:12288
    ds_read_b64_tr_b16 v[202:203], v14 offset:13312
    ds_read_b64_tr_b16 v[204:205], v15 offset:12288
    ds_read_b64_tr_b16 v[206:207], v15 offset:13312
    s_waitcnt lgkmcnt(8)
    s_addk_i32 m0, 2048
    s_addk_i32 s13, 14336
    s_waitcnt vmcnt(9)
    buffer_load_dwordx4 v12, s[40:43], s13 offen offset:0 lds
    s_waitcnt vmcnt(9)
    buffer_load_dwordx4 v13, s[40:43], s13 offen offset:1024 lds
    ds_read_b64_tr_b16 v[208:209], v14 offset:14336
    ds_read_b64_tr_b16 v[210:211], v14 offset:15360
    ds_read_b64_tr_b16 v[212:213], v15 offset:14336
    ds_read_b64_tr_b16 v[214:215], v15 offset:15360
    s_waitcnt lgkmcnt(0)
    s_and_b64 s[84:85], s[84:85], s[86:87]
    s_and_b32 s84, s84, s85
    s_and_b32 s84, s84, 1
    s_cbranch_scc0 L_poll_21
L_pend_22:
    s_load_dwordx4 s[84:87], s[14:15], 0 glc
    s_waitcnt vmcnt(9)
    buffer_load_dwordx4 v[96:99], v21, s[36:39], 0 offen offset:0 sc1
    s_waitcnt vmcnt(9)
    buffer_load_dwordx4 v[100:103], v20, s[36:39], 0 offen offset:0 sc1
    ds_read_b64_tr_b16 v[216:217], v14 offset:0
    ds_read_b64_tr_b16 v[218:219], v14 offset:1024
    ds_read_b64_tr_b16 v[220:221], v15 offset:0
    ds_read_b64_tr_b16 v[222:223], v15 offset:1024
    s_waitcnt vmcnt(9)
    buffer_load_dwordx4 v[104:107], v21, s[36:39], 0 offen offset:1024 sc1
    s_waitcnt vmcnt(9)
    buffer_load_dwordx4 v[108:111], v20, s[36:39], 0 offen offset:1024 sc1
    ds_read_b64_tr_b16 v[224:225], v14 offset:2048
    ds_read_b64_tr_b16 v[226:227], v14 offset:3072
    ds_read_b64_tr_b16 v[228:229], v15 offset:2048
    ds_read_b64_tr_b16 v[230:231], v15 offset:3072
    s_waitcnt vmcnt(9)
    buffer_load_dwordx4 v[112:115], v21, s[36:39], 0 offen offset:2048 sc1
    s_waitcnt vmcnt(9)
    buffer_load_dwordx4 v[116:119], v20, s[36:39], 0 offen offset:2048 sc1
    ds_read_b64_tr_b16 v[232:233], v14 offset:4096
    ds_read_b64_tr_b16 v[234:235], v14 offset:5120
    ds_read_b64_tr_b16 v[236:237], v15 offset:4096
    ds_read_b64_tr_b16 v[238:239], v15 offset:5120
    s_waitcnt vmcnt(9)
    buffer_load_dwordx4 v[120:123], v21, s[36:39], 0 offen offset:3072 sc1
    s_waitcnt vmcnt(9)
    buffer_load_dwordx4 v[124:127], v20, s[36:39], 0 offen offset:3072 sc1
    ds_read_b64_tr_b16 v[240:241], v14 offset:6144
    ds_read_b64_tr_b16 v[242:243], v14 offset:7168
    ds_read_b64_tr_b16 v[244:245], v15 offset:6144
    ds_read_b64_tr_b16 v[246:247], v15 offset:7168
    s_waitcnt lgkmcnt(0)
    s_and_b64 s[84:85], s[84:85], s[86:87]
    s_and_b32 s84, s84, s85
    s_and_b32 s84, s84, 2
    s_cbranch_scc0 L_poll_23
L_pend_24:
    s_waitcnt vmcnt(9)
    buffer_load_dwordx4 v[128:131], v21, s[36:39], s16 offen offset:0 sc1
    s_waitcnt vmcnt(8)
    v_mfma_f32_32x32x16_bf16 v[80:95], v[148:151], v[96:99], 0
    ds_read_b64_tr_b16 v[248:249], v14 offset:8192
    ds_read_b64_tr_b16 v[250:251], v14 offset:9216
    v_mfma_f32_32x32x16_bf16 v[64:79], v[144:147], v[96:99], 0
    buffer_load_dwordx4 v[132:135], v20, s[36:39], s16 offen offset:0 sc1
    ds_read_b64_tr_b16 v[252:253], v15 offset:8192
    ds_read_b64_tr_b16 v[254:255], v15 offset:9216
    s_waitcnt vmcnt(8)
    v_mfma_f32_32x32x16_bf16 v[48:63], v[148:151], v[100:103], 0
    v_mfma_f32_32x32x16_bf16 v[32:47], v[144:147], v[100:103], 0
    buffer_load_dwordx4 v[136:139], v21, s[36:39], s16 offen offset:1024 sc1
    s_waitcnt vmcnt(8)
    v_mfma_f32_32x32x16_bf16 v[80:95], v[156:159], v[104:107], v[80:95]
    v_mfma_f32_32x32x16_bf16 v[64:79], v[152:155], v[104:107], v[64:79]
    buffer_load_dwordx4 v[140:143], v20, s[36:39], s16 offen offset:1024 sc1
    s_waitcnt vmcnt(8)
    v_mfma_f32_32x32x16_bf16 v[48:63], v[156:159], v[108:111], v[48:63]
    v_mfma_f32_32x32x16_bf16 v[32:47], v[152:155], v[108:111], v[32:47]
    buffer_load_dwordx4 v[96:99], v21, s[36:39], s16 offen offset:2048 sc1
    s_waitcnt vmcnt(8)
    v_mfma_f32_32x32x16_bf16 v[80:95], v[164:167], v[112:115], v[80:95]
    v_mfma_f32_32x32x16_bf16 v[64:79], v[160:163], v[112:115], v[64:79]
    buffer_load_dwordx4 v[100:103], v20, s[36:39], s16 offen offset:2048 sc1
    s_waitcnt vmcnt(8)
    v_mfma_f32_32x32x16_bf16 v[48:63], v[164:167], v[116:119], v[48:63]
    v_mfma_f32_32x32x16_bf16 v[32:47], v[160:163], v[116:119], v[32:47]
    buffer_load_dwordx4 v[104:107], v21, s[36:39], s16 offen offset:3072 sc1
    s_waitcnt vmcnt(8)
    v_mfma_f32_32x32x16_bf16 v[80:95], v[172:175], v[120:123], v[80:95]
    v_mfma_f32_32x32x16_bf16 v[64:79], v[168:171], v[120:123], v[64:79]
    buffer_load_dwordx4 v[108:111], v20, s[36:39], s16 offen offset:3072 sc1
    s_waitcnt vmcnt(8)
    v_mfma_f32_32x32x16_bf16 v[48:63], v[172:175], v[124:127], v[48:63]
    v_mfma_f32_32x32x16_bf16 v[32:47], v[168:171], v[124:127], v[32:47]
    s_addk_i32 m0, 2048
    s_add_u32 s13, s5, 0
    buffer_load_dwordx4 v12, s[40:43], s13 offen offset:0 lds
    s_waitcnt vmcnt(8)
    v_mfma_f32_32x32x16_bf16 v[80:95], v[180:183], v[128:131], v[80:95]
    v_mfma_f32_32x32x16_bf16 v[64:79], v[176:179], v[128:131], v[64:79]
    buffer_load_dwordx4 v13, s[40:43], s13 offen offset:1024 lds
    s_waitcnt vmcnt(8)
    v_mfma_f32_32x32x16_bf16 v[48:63], v[180:183], v[132:135], v[48:63]
    v_mfma_f32_32x32x16_bf16 v[32:47], v[176:179], v[132:135], v[32:47]
    s_addk_i32 m0, 2048
    s_addk_i32 s13, 14336
    buffer_load_dwordx4 v12, s[40:43], s13 offen offset:0 lds
    s_waitcnt vmcnt(8)
    v_mfma_f32_32x32x16_bf16 v[80:95], v[188:191], v[136:139], v[80:95]
    v_mfma_f32_32x32x16_bf16 v[64:79], v[184:187], v[136:139], v[64:79]
    buffer_load_dwordx4 v13, s[40:43], s13 offen offset:1024 lds
    s_waitcnt vmcnt(8)
    v_mfma_f32_32x32x16_bf16 v[48:63], v[188:191], v[140:143], v[48:63]
    v_mfma_f32_32x32x16_bf16 v[32:47], v[184:187], v[140:143], v[32:47]
    s_addk_i32 m0, 2048
    s_add_u32 s13, s76, 0
    buffer_load_dwordx4 v12, s[44:47], s13 offen offset:0 lds
    s_waitcnt vmcnt(8)
    v_mfma_f32_32x32x16_bf16 v[80:95], v[196:199], v[96:99], v[80:95]
    v_mfma_f32_32x32x16_bf16 v[64:79], v[192:195], v[96:99], v[64:79]
    buffer_load_dwordx4 v13, s[44:47], s13 offen offset:1024 lds
    s_waitcnt vmcnt(8)
    v_mfma_f32_32x32x16_bf16 v[48:63], v[196:199], v[100:103], v[48:63]
    s_load_dwordx4 s[84:87], s[14:15], 0 glc
    v_mfma_f32_32x32x16_bf16 v[32:47], v[192:195], v[100:103], v[32:47]
    s_addk_i32 m0, -14336
    s_addk_i32 s13, 14336
    buffer_load_dwordx4 v12, s[44:47], s13 offen offset:0 lds
    s_waitcnt vmcnt(8)
    v_mfma_f32_32x32x16_bf16 v[80:95], v[204:207], v[104:107], v[80:95]
    v_mfma_f32_32x32x16_bf16 v[64:79], v[200:203], v[104:107], v[64:79]
    buffer_load_dwordx4 v13, s[44:47], s13 offen offset:1024 lds
    s_waitcnt vmcnt(8)
    v_mfma_f32_32x32x16_bf16 v[48:63], v[204:207], v[108:111], v[48:63]
    v_mfma_f32_32x32x16_bf16 v[32:47], v[200:203], v[108:111], v[32:47]
    s_addk_i32 m0, 2048
    s_addk_i32 s13, 14336
    buffer_load_dwordx4 v12, s[44:47], s13 offen offset:0 lds
    buffer_load_dwordx4 v13, s[44:47], s13 offen offset:1024 lds
    s_addk_i32 m0, 2048
    s_addk_i32 s13, 14336
    s_waitcnt vmcnt(9)
    buffer_load_dwordx4 v12, s[44:47], s13 offen offset:0 lds
    s_waitcnt vmcnt(9)
    buffer_load_dwordx4 v13, s[44:47], s13 offen offset:1024 lds
    s_addk_i32 m0, 2048
    s_addk_i32 s13, 14336
    s_waitcnt vmcnt(9)
    buffer_load_dwordx4 v12, s[44:47], s13 offen offset:0 lds
    s_waitcnt vmcnt(9)
    buffer_load_dwordx4 v13, s[44:47], s13 offen offset:1024 lds
    s_waitcnt lgkmcnt(0)
    s_and_b64 s[84:85], s[84:85], s[86:87]
    s_and_b32 s84, s84, s85
    s_and_b32 s84, s84, 4
    s_cbranch_scc0 L_poll_25
L_pend_26:
    s_waitcnt vmcnt(9)
    buffer_load_dwordx4 v[112:115], v21, s[36:39], s17 offen offset:0 sc1
    s_waitcnt vmcnt(9)
    buffer_load_dwordx4 v[116:119], v21, s[36:39], s17 offen offset:1024 sc1
    s_waitcnt vmcnt(9)
    buffer_load_dwordx4 v[120:123], v21, s[36:39], s17 offen offset:2048 sc1
    s_waitcnt vmcnt(9)
    buffer_load_dwordx4 v[124:127], v21, s[36:39], s17 offen offset:3072 sc1
    s_waitcnt vmcnt(9)
    buffer_load_dwordx4 v[128:131], v20, s[36:39], s17 offen offset:0 sc1
    s_waitcnt vmcnt(9)
    buffer_load_dwordx4 v[132:135], v20, s[36:39], s17 offen offset:1024 sc1
    s_waitcnt vmcnt(9)
    buffer_load_dwordx4 v[136:139], v20, s[36:39], s17 offen offset:2048 sc1
    s_waitcnt vmcnt(9)
    buffer_load_dwordx4 v[140:143], v20, s[36:39], s17 offen offset:3072 sc1
    s_barrier
    buffer_load_dwordx4 v[96:99], v3, s[36:39], s17 offen offset:3072 sc1
    s_waitcnt vmcnt(8)
    v_mfma_f32_32x32x16_bf16 v[80:95], v[212:215], v[112:115], v[80:95]
    v_mfma_f32_32x32x16_bf16 v[64:79], v[208:211], v[112:115], v[64:79]
    buffer_load_dwordx4 v[100:103], v3, s[36:39], s17 offen offset:2048 sc1
    s_waitcnt vmcnt(8)
    v_mfma_f32_32x32x16_bf16 v[80:95], v[220:223], v[116:119], v[80:95]
    v_mfma_f32_32x32x16_bf16 v[64:79], v[216:219], v[116:119], v[64:79]
    buffer_load_dwordx4 v[104:107], v3, s[36:39], s17 offen offset:1024 sc1
    s_waitcnt vmcnt(8)
    v_mfma_f32_32x32x16_bf16 v[80:95], v[228:231], v[120:123], v[80:95]
    v_mfma_f32_32x32x16_bf16 v[64:79], v[224:227], v[120:123], v[64:79]
    buffer_load_dwordx4 v[108:111], v3, s[36:39], s17 offen offset:0 sc1
    s_waitcnt vmcnt(8)
    v_mfma_f32_32x32x16_bf16 v[80:95], v[236:239], v[124:127], v[80:95]
    v_mfma_f32_32x32x16_bf16 v[64:79], v[232:235], v[124:127], v[64:79]
    buffer_load_dwordx4 v[112:115], v2, s[36:39], s17 offen offset:3072 sc1
    s_waitcnt vmcnt(8)
    v_mfma_f32_32x32x16_bf16 v[48:63], v[212:215], v[128:131], v[48:63]
    v_mfma_f32_32x32x16_bf16 v[32:47], v[208:211], v[128:131], v[32:47]
    buffer_load_dwordx4 v[116:119], v2, s[36:39], s17 offen offset:2048 sc1
    s_waitcnt vmcnt(8)
    v_mfma_f32_32x32x16_bf16 v[48:63], v[220:223], v[132:135], v[48:63]
    s_nop 3
    ds_write_b128 v27, v[80:83] offset:13056
    v_mfma_f32_32x32x16_bf16 v[32:47], v[216:219], v[132:135], v[32:47]
    buffer_load_dwordx4 v[120:123], v2, s[36:39], s17 offen offset:1024 sc1
    ds_write_b128 v27, v[84:87] offset:14144
    s_waitcnt vmcnt(8)
    v_mfma_f32_32x32x16_bf16 v[48:63], v[228:231], v[136:139], v[48:63]
    ds_write_b128 v27, v[88:91] offset:15232
    v_mfma_f32_32x32x16_bf16 v[32:47], v[224:227], v[136:139], v[32:47]
    buffer_load_dwordx4 v[124:127], v2, s[36:39], s17 offen offset:0 sc1
    ds_write_b128 v27, v[92:95] offset:16320
    s_waitcnt vmcnt(8)
    v_mfma_f32_32x32x16_bf16 v[48:63], v[236:239], v[140:143], v[48:63]
    ds_write_b128 v26, v[64:67] offset:8704
    v_mfma_f32_32x32x16_bf16 v[32:47], v[232:235], v[140:143], v[32:47]
    buffer_load_dwordx4 v[128:131], v3, s[36:39], s16 offen offset:3072 sc1
    ds_write_b128 v26, v[68:71] offset:9792
    ds_write_b128 v26, v[72:75] offset:10880
    buffer_load_dwordx4 v[132:135], v2, s[36:39], s16 offen offset:3072 sc1
    ds_write_b128 v26, v[76:79] offset:11968
    s_waitcnt vmcnt(9) lgkmcnt(0)
    v_mfma_f32_32x32x16_bf16 v[80:95], v[236:239], v[96:99], 0
    s_nop 2
    ds_write_b128 v25, v[48:51] offset:4352
    v_mfma_f32_32x32x16_bf16 v[64:79], v[232:235], v[96:99], 0
    s_addk_i32 m0, 2048
    s_addk_i32 s13, 14336
    buffer_load_dwordx4 v12, s[44:47], s13 offen offset:0 lds
    ds_write_b128 v25, v[52:55] offset:5440
    s_waitcnt vmcnt(9)
    v_mfma_f32_32x32x16_bf16 v[80:95], v[228:231], v[100:103], v[80:95]
    ds_write_b128 v25, v[56:59] offset:6528
    v_mfma_f32_32x32x16_bf16 v[64:79], v[224:227], v[100:103], v[64:79]
    buffer_load_dwordx4 v13, s[44:47], s13 offen offset:1024 lds
    ds_write_b128 v25, v[60:63] offset:7616
    s_waitcnt vmcnt(9)
    v_mfma_f32_32x32x16_bf16 v[80:95], v[220:223], v[104:107], v[80:95]
    ds_write_b128 v24, v[32:35] offset:0
    v_mfma_f32_32x32x16_bf16 v[64:79], v[216:219], v[104:107], v[64:79]
    buffer_load_dwordx4 v[136:139], v3, s[36:39], s16 offen offset:2048 sc1
    ds_write_b128 v24, v[36:39] offset:1088
    s_waitcnt vmcnt(9)
    v_mfma_f32_32x32x16_bf16 v[80:95], v[212:215], v[108:111], v[80:95]
    ds_write_b128 v24, v[40:43] offset:2176
    v_mfma_f32_32x32x16_bf16 v[64:79], v[208:211], v[108:111], v[64:79]
    buffer_load_dwordx4 v[140:143], v2, s[36:39], s16 offen offset:2048 sc1
    ds_write_b128 v24, v[44:47] offset:3264
    s_waitcnt lgkmcnt(0)
    s_barrier
    s_waitcnt vmcnt(9)
    v_mfma_f32_32x32x16_bf16 v[48:63], v[236:239], v[112:115], 0
    s_load_dwordx4 s[84:87], s[14:15], 0 glc
    v_mfma_f32_32x32x16_bf16 v[32:47], v[232:235], v[112:115], 0
    buffer_load_dwordx4 v[96:99], v3, s[36:39], s16 offen offset:1024 sc1
    s_waitcnt vmcnt(9)
    v_mfma_f32_32x32x16_bf16 v[48:63], v[228:231], v[116:119], v[48:63]
    v_mfma_f32_32x32x16_bf16 v[32:47], v[224:227], v[116:119], v[32:47]
    buffer_load_dwordx4 v[100:103], v2, s[36:39], s16 offen offset:1024 sc1
    ds_read_b64_tr_b16 v[224:225], v14 offset:10240
    ds_read_b64_tr_b16 v[226:227], v14 offset:11264
    s_waitcnt vmcnt(9)
    v_mfma_f32_32x32x16_bf16 v[48:63], v[220:223], v[120:123], v[48:63]
    ds_read_b64_tr_b16 v[228:229], v15 offset:10240
    ds_read_b64_tr_b16 v[230:231], v15 offset:11264
    v_mfma_f32_32x32x16_bf16 v[32:47], v[216:219], v[120:123], v[32:47]
    buffer_load_dwordx4 v[104:107], v3, s[36:39], s16 offen offset:0 sc1
    ds_read_b64_tr_b16 v[216:217], v14 offset:12288
    ds_read_b64_tr_b16 v[218:219], v14 offset:13312
    s_waitcnt vmcnt(9)
    v_mfma_f32_32x32x16_bf16 v[48:63], v[212:215], v[124:127], v[48:63]
    ds_read_b64_tr_b16 v[220:221], v15 offset:12288
    ds_read_b64_tr_b16 v[222:223], v15 offset:13312
    v_mfma_f32_32x32x16_bf16 v[32:47], v[208:211], v[124:127], v[32:47]
    buffer_load_dwordx4 v[108:111], v2, s[36:39], s16 offen offset:0 sc1
    ds_read_b64_tr_b16 v[208:209], v14 offset:14336
    ds_read_b64_tr_b16 v[210:211], v14 offset:15360
    s_waitcnt vmcnt(9)
    v_mfma_f32_32x32x16_bf16 v[80:95], v[204:207], v[128:131], v[80:95]
    ds_read_b64_tr_b16 v[212:213], v15 offset:14336
    ds_read_b64_tr_b16 v[214:215], v15 offset:15360
    v_mfma_f32_32x32x16_bf16 v[64:79], v[200:203], v[128:131], v[64:79]
    buffer_load_dwordx4 v[112:115], v3, s[36:39], 0 offen offset:3072 sc1
    s_waitcnt vmcnt(9)
    v_mfma_f32_32x32x16_bf16 v[48:63], v[204:207], v[132:135], v[48:63]
    v_mfma_f32_32x32x16_bf16 v[32:47], v[200:203], v[132:135], v[32:47]
    buffer_load_dwordx4 v[116:119], v2, s[36:39], 0 offen offset:3072 sc1
    ds_read_b64_tr_b16 v[200:201], v14 offset:0
    ds_read_b64_tr_b16 v[202:203], v14 offset:1024
    ds_read_b64_tr_b16 v[204:205], v15 offset:0
    ds_read_b64_tr_b16 v[206:207], v15 offset:1024
    s_waitcnt vmcnt(7)
    v_mfma_f32_32x32x16_bf16 v[80:95], v[196:199], v[136:139], v[80:95]
    v_mfma_f32_32x32x16_bf16 v[64:79], v[192:195], v[136:139], v[64:79]
    s_waitcnt vmcnt(6)
    v_mfma_f32_32x32x16_bf16 v[48:63], v[196:199], v[140:143], v[48:63]
    v_mfma_f32_32x32x16_bf16 v[32:47], v[192:195], v[140:143], v[32:47]
    ds_read_b64_tr_b16 v[192:193], v14 offset:2048
    ds_read_b64_tr_b16 v[194:195], v14 offset:3072
    s_waitcnt vmcnt(5)
    v_mfma_f32_32x32x16_bf16 v[80:95], v[188:191], v[96:99], v[80:95]
    ds_read_b64_tr_b16 v[196:197], v15 offset:2048
    ds_read_b64_tr_b16 v[198:199], v15 offset:3072
    v_mfma_f32_32x32x16_bf16 v[64:79], v[184:187], v[96:99], v[64:79]
    s_waitcnt vmcnt(4)
    v_mfma_f32_32x32x16_bf16 v[48:63], v[188:191], v[100:103], v[48:63]
    v_mfma_f32_32x32x16_bf16 v[32:47], v[184:187], v[100:103], v[32:47]
    ds_read_b64_tr_b16 v[184:185], v14 offset:4096
    ds_read_b64_tr_b16 v[186:187], v14 offset:5120
    s_waitcnt lgkmcnt(0)
    s_and_b64 s[84:85], s[84:85], s[86:87]
    s_and_b32 s84, s84, s85
    s_and_b32 s84, s84, 8
    s_cbranch_scc0 L_poll_27
L_pend_28:
    s_load_dwordx4 s[84:87], s[92:93], 0 glc
    buffer_load_dwordx4 v[120:123], v3, s[36:39], 0 offen offset:2048 sc1
    ds_read_b64_tr_b16 v[188:189], v15 offset:4096
    ds_read_b64_tr_b16 v[190:191], v15 offset:5120
    s_addk_i32 m0, 2048
    s_addk_i32 s13, 14336
    buffer_load_dwordx4 v12, s[44:47], s13 offen offset:0 lds
    buffer_load_dwordx4 v[124:127], v2, s[36:39], 0 offen offset:2048 sc1
    buffer_load_dwordx4 v13, s[44:47], s13 offen offset:1024 lds
    buffer_load_dwordx4 v[128:131], v3, s[36:39], 0 offen offset:1024 sc1
    s_waitcnt vmcnt(8)
    v_mfma_f32_32x32x16_bf16 v[80:95], v[180:183], v[104:107], v[80:95]
    v_mfma_f32_32x32x16_bf16 v[64:79], v[176:179], v[104:107], v[64:79]
    buffer_load_dwordx4 v[132:135], v2, s[36:39], 0 offen offset:1024 sc1
    s_waitcnt vmcnt(8)
    v_mfma_f32_32x32x16_bf16 v[48:63], v[180:183], v[108:111], v[48:63]
    v_mfma_f32_32x32x16_bf16 v[32:47], v[176:179], v[108:111], v[32:47]
    buffer_load_dwordx4 v[136:139], v3, s[36:39], 0 offen offset:0 sc1
    ds_read_b64_tr_b16 v[176:177], v14 offset:6144
    ds_read_b64_tr_b16 v[178:179], v14 offset:7168
    s_waitcnt vmcnt(8)
    v_mfma_f32_32x32x16_bf16 v[80:95], v[172:175], v[112:115], v[80:95]
    ds_read_b64_tr_b16 v[180:181], v15 offset:6144
    ds_read_b64_tr_b16 v[182:183], v15 offset:7168
    v_mfma_f32_32x32x16_bf16 v[64:79], v[168:171], v[112:115], v[64:79]
    buffer_load_dwordx4 v[140:143], v2, s[36:39], 0 offen offset:0 sc1
    s_waitcnt vmcnt(8)
    v_mfma_f32_32x32x16_bf16 v[48:63], v[172:175], v[116:119], v[48:63]
    s_waitcnt lgkmcnt(0)
    s_and_b64 s[84:85], s[84:85], s[86:87]
    s_and_b32 s84, s84, s85
    s_and_b32 s84, s84, 8
    s_cbranch_scc0 L_poll_29
L_pend_30:
    s_load_dwordx2 s[84:85], s[14:15], 16 glc
    v_mfma_f32_32x32x16_bf16 v[32:47], v[168:171], v[116:119], v[32:47]
    buffer_load_dwordx4 v[96:99], v3, s[36:39], s18 offen offset:0 sc1
    ds_read_b64_tr_b16 v[168:169], v14 offset:8192
    ds_read_b64_tr_b16 v[170:171], v14 offset:9216
    s_waitcnt vmcnt(8)
    v_mfma_f32_32x32x16_bf16 v[80:95], v[164:167], v[120:123], v[80:95]
    ds_read_b64_tr_b16 v[172:173], v15 offset:8192
    ds_read_b64_tr_b16 v[174:175], v15 offset:9216
    v_mfma_f32_32x32x16_bf16 v[64:79], v[160:163], v[120:123], v[64:79]
    buffer_load_dwordx4 v[100:103], v2, s[36:39], s18 offen offset:0 sc1
    buffer_load_dwordx4 v[104:107], v3, s[36:39], s18 offen offset:1024 sc1
    s_waitcnt vmcnt(8)
    v_mfma_f32_32x32x16_bf16 v[48:63], v[164:167], v[124:127], v[48:63]
    v_mfma_f32_32x32x16_bf16 v[32:47], v[160:163], v[124:127], v[32:47]
    buffer_load_dwordx4 v[108:111], v2, s[36:39], s18 offen offset:1024 sc1
    buffer_load_dwordx4 v[112:115], v3, s[36:39], s95 offen offset:0 sc1
    s_waitcnt vmcnt(8)
    v_mfma_f32_32x32x16_bf16 v[80:95], v[156:159], v[128:131], v[80:95]
    ds_read_b64_tr_b16 v[160:161], v14 offset:10240
    ds_read_b64_tr_b16 v[162:163], v14 offset:11264
    v_mfma_f32_32x32x16_bf16 v[64:79], v[152:155], v[128:131], v[64:79]
    buffer_load_dwordx4 v[116:119], v2, s[36:39], s95 offen offset:0 sc1
    ds_read_b64_tr_b16 v[164:165], v15 offset:10240
    ds_read_b64_tr_b16 v[166:167], v15 offset:11264
    s_waitcnt vmcnt(8)
    v_mfma_f32_32x32x16_bf16 v[48:63], v[156:159], v[132:135], v[48:63]
    v_mfma_f32_32x32x16_bf16 v[32:47], v[152:155], v[132:135], v[32:47]
    buffer_load_dwordx4 v[120:123], v3, s[36:39], s95 offen offset:1024 sc1
    s_waitcnt vmcnt(8)
    v_mfma_f32_32x32x16_bf16 v[80:95], v[148:151], v[136:139], v[80:95]
    v_mfma_f32_32x32x16_bf16 v[64:79], v[144:147], v[136:139], v[64:79]
    buffer_load_dwordx4 v[124:127], v2, s[36:39], s95 offen offset:1024 sc1
    s_waitcnt vmcnt(8)
    v_mfma_f32_32x32x16_bf16 v[48:63], v[148:151], v[140:143], v[48:63]
    s_waitcnt lgkmcnt(0)
    s_and_b32 s84, s84, s85
    s_and_b32 s84, s84, 1
    s_cbranch_scc0 L_poll_31
L_pend_32:
    v_mfma_f32_32x32x16_bf16 v[32:47], v[144:147], v[140:143], v[32:47]
    buffer_load_dwordx4 v[128:131], v3, s[36:39], s19 offen offset:0 sc1
    s_waitcnt vmcnt(8)
    v_mfma_f32_32x32x16_bf16 v[80:95], v[244:247], v[96:99], v[80:95]
    v_mfma_f32_32x32x16_bf16 v[64:79], v[240:243], v[96:99], v[64:79]
    buffer_load_dwordx4 v[132:135], v3, s[36:39], s19 offen offset:1024 sc1
    s_waitcnt vmcnt(8)
    v_mfma_f32_32x32x16_bf16 v[48:63], v[244:247], v[100:103], v[48:63]
    v_mfma_f32_32x32x16_bf16 v[32:47], v[240:243], v[100:103], v[32:47]
    buffer_load_dwordx4 v[136:139], v3, s[36:39], s19 offen offset:2048 sc1
    s_waitcnt vmcnt(8)
    v_mfma_f32_32x32x16_bf16 v[80:95], v[252:255], v[104:107], v[80:95]
    v_mfma_f32_32x32x16_bf16 v[64:79], v[248:251], v[104:107], v[64:79]
    buffer_load_dwordx4 v[140:143], v3, s[36:39], s19 offen offset:3072 sc1
    s_waitcnt vmcnt(8)
    v_mfma_f32_32x32x16_bf16 v[48:63], v[252:255], v[108:111], v[48:63]
    v_mfma_f32_32x32x16_bf16 v[32:47], v[248:251], v[108:111], v[32:47]
    buffer_load_dwordx4 v[96:99], v3, s[36:39], s20 offen offset:0 sc1
    s_waitcnt vmcnt(8)
    v_mfma_f32_32x32x16_bf16 v[80:95], v[228:231], v[112:115], v[80:95]
    v_mfma_f32_32x32x16_bf16 v[64:79], v[224:227], v[112:115], v[64:79]
    buffer_load_dwordx4 v[100:103], v3, s[36:39], s20 offen offset:1024 sc1
    s_waitcnt vmcnt(8)
    v_mfma_f32_32x32x16_bf16 v[48:63], v[228:231], v[116:119], v[48:63]
    s_load_dword s84, s[14:15], s22 glc
    v_mfma_f32_32x32x16_bf16 v[32:47], v[224:227], v[116:119], v[32:47]
    buffer_load_dwordx4 v[104:107], v3, s[36:39], s20 offen offset:2048 sc1
    s_waitcnt vmcnt(8)
    v_mfma_f32_32x32x16_bf16 v[80:95], v[220:223], v[120:123], v[80:95]
    v_mfma_f32_32x32x16_bf16 v[64:79], v[216:219], v[120:123], v[64:79]
    buffer_load_dwordx4 v[108:111], v2, s[36:39], s19 offen offset:0 sc1
    s_waitcnt vmcnt(8)
    v_mfma_f32_32x32x16_bf16 v[48:63], v[220:223], v[124:127], v[48:63]
    v_mfma_f32_32x32x16_bf16 v[32:47], v[216:219], v[124:127], v[32:47]
    buffer_load_dwordx4 v[112:115], v2, s[36:39], s19 offen offset:1024 sc1
    s_waitcnt vmcnt(8)
    v_mfma_f32_32x32x16_bf16 v[80:95], v[212:215], v[128:131], v[80:95]
    v_mfma_f32_32x32x16_bf16 v[64:79], v[208:211], v[128:131], v[64:79]
    buffer_load_dwordx4 v[116:119], v2, s[36:39], s19 offen offset:2048 sc1
    s_waitcnt vmcnt(8)
    v_mfma_f32_32x32x16_bf16 v[80:95], v[204:207], v[132:135], v[80:95]
    v_mfma_f32_32x32x16_bf16 v[64:79], v[200:203], v[132:135], v[64:79]
    buffer_load_dwordx4 v[120:123], v2, s[36:39], s19 offen offset:3072 sc1
    s_waitcnt vmcnt(8)
    v_mfma_f32_32x32x16_bf16 v[80:95], v[196:199], v[136:139], v[80:95]
    v_mfma_f32_32x32x16_bf16 v[64:79], v[192:195], v[136:139], v[64:79]
    buffer_load_dwordx4 v[124:127], v2, s[36:39], s20 offen offset:0 sc1
    s_waitcnt vmcnt(8)
    v_mfma_f32_32x32x16_bf16 v[80:95], v[188:191], v[140:143], v[80:95]
    v_mfma_f32_32x32x16_bf16 v[64:79], v[184:187], v[140:143], v[64:79]
    buffer_load_dwordx4 v[128:131], v2, s[36:39], s20 offen offset:1024 sc1
    s_waitcnt vmcnt(8)
    v_mfma_f32_32x32x16_bf16 v[80:95], v[180:183], v[96:99], v[80:95]
    v_mfma_f32_32x32x16_bf16 v[64:79], v[176:179], v[96:99], v[64:79]
    buffer_load_dwordx4 v[132:135], v2, s[36:39], s20 offen offset:2048 sc1
    s_waitcnt vmcnt(8)
    v_mfma_f32_32x32x16_bf16 v[80:95], v[172:175], v[100:103], v[80:95]
    s_waitcnt lgkmcnt(0)
    s_and_b32 s84, s84, 1
    s_cbranch_scc0 L_poll_33
L_pend_34:
    v_mfma_f32_32x32x16_bf16 v[64:79], v[168:171], v[100:103], v[64:79]
    buffer_load_dwordx4 v[248:251], v18, s[36:39], s21 offen offset:0 sc1
    buffer_load_dwordx4 v[252:255], v18, s[36:39], s21 offen offset:1024 sc1
    s_waitcnt vmcnt(9)
    v_mfma_f32_32x32x16_bf16 v[80:95], v[164:167], v[104:107], v[80:95]
    s_barrier
    v_mfma_f32_32x32x16_bf16 v[64:79], v[160:163], v[104:107], v[64:79]
    s_waitcnt vmcnt(8)
    v_mfma_f32_32x32x16_bf16 v[48:63], v[212:215], v[108:111], v[48:63]
    v_mfma_f32_32x32x16_bf16 v[32:47], v[208:211], v[108:111], v[32:47]
    s_waitcnt vmcnt(7)
    v_mfma_f32_32x32x16_bf16 v[48:63], v[204:207], v[112:115], v[48:63]
    s_nop 4
    ds_write_b128 v27, v[80:83] offset:13056
    v_mfma_f32_32x32x16_bf16 v[32:47], v[200:203], v[112:115], v[32:47]
    ds_write_b128 v27, v[84:87] offset:14144
    s_waitcnt vmcnt(6)
    v_mfma_f32_32x32x16_bf16 v[48:63], v[196:199], v[116:119], v[48:63]
    ds_write_b128 v27, v[88:91] offset:15232
    v_mfma_f32_32x32x16_bf16 v[32:47], v[192:195], v[116:119], v[32:47]
    ds_write_b128 v27, v[92:95] offset:16320
    s_waitcnt vmcnt(5)
    v_mfma_f32_32x32x16_bf16 v[48:63], v[188:191], v[120:123], v[48:63]
    ds_write_b128 v26, v[64:67] offset:8704
    v_mfma_f32_32x32x16_bf16 v[32:47], v[184:187], v[120:123], v[32:47]
    ds_write_b128 v26, v[68:71] offset:9792
    s_waitcnt vmcnt(4)
    v_mfma_f32_32x32x16_bf16 v[48:63], v[180:183], v[124:127], v[48:63]
    ds_write_b128 v26, v[72:75] offset:10880
    v_mfma_f32_32x32x16_bf16 v[32:47], v[176:179], v[124:127], v[32:47]
    ds_write_b128 v26, v[76:79] offset:11968
    s_waitcnt vmcnt(3)
    v_mfma_f32_32x32x16_bf16 v[48:63], v[172:175], v[128:131], v[48:63]
    v_mfma_f32_32x32x16_bf16 v[32:47], v[168:171], v[128:131], v[32:47]
    s_waitcnt vmcnt(2)
    v_mfma_f32_32x32x16_bf16 v[48:63], v[164:167], v[132:135], v[48:63]
    v_mfma_f32_32x32x16_bf16 v[32:47], v[160:163], v[132:135], v[32:47]
    s_waitcnt vmcnt(0)
    v_lshlrev_b32 v232, 16, v248
    v_and_b32 v233, s10, v248
    v_lshlrev_b32 v234, 16, v249
    v_and_b32 v235, s10, v249
    v_lshlrev_b32 v236, 16, v250
    v_and_b32 v237, s10, v250
    v_lshlrev_b32 v238, 16, v251
    v_and_b32 v239, s10, v251
    v_lshlrev_b32 v240, 16, v252
    v_and_b32 v241, s10, v252
    ds_write_b128 v25, v[48:51] offset:4352
    v_lshlrev_b32 v242, 16, v253
    v_and_b32 v243, s10, v253
    v_lshlrev_b32 v244, 16, v254
    v_and_b32 v245, s10, v254
    v_lshlrev_b32 v246, 16, v255
    ds_write_b128 v25, v[52:55] offset:5440
    v_and_b32 v247, s10, v255
    ds_write_b128 v25, v[56:59] offset:6528
    ds_write_b128 v25, v[60:63] offset:7616
    ds_write_b128 v24, v[32:35] offset:0
    ds_write_b128 v24, v[36:39] offset:1088
    ds_write_b128 v24, v[40:43] offset:2176
    ds_write_b128 v24, v[44:47] offset:3264
    s_waitcnt lgkmcnt(0)
    s_barrier
    ds_read_b128 v[32:35], v17 offset:0
    ds_read_b128 v[48:51], v17 offset:4352
    ds_read_b128 v[64:67], v17 offset:8704
    ds_read_b128 v[80:83], v17 offset:13056
    ds_read_b128 v[36:39], v17 offset:512
    ds_read_b128 v[52:55], v17 offset:4864
    ds_read_b128 v[68:71], v17 offset:9216
    ds_read_b128 v[84:87], v17 offset:13568
    ds_read_b128 v[40:43], v17 offset:256
    ds_read_b128 v[56:59], v17 offset:4608
    ds_read_b128 v[72:75], v17 offset:8960
    ds_read_b128 v[88:91], v17 offset:13312
    ds_read_b128 v[44:47], v17 offset:768
    ds_read_b128 v[60:63], v17 offset:5120
    ds_read_b128 v[76:79], v17 offset:9472
    ds_read_b128 v[92:95], v17 offset:13824
    s_waitcnt lgkmcnt(12)
    v_pk_add_f32 v[32:33], v[32:33], v[48:49]
    v_pk_add_f32 v[64:65], v[64:65], v[80:81]
    v_pk_add_f32 v[32:33], v[32:33], v[232:233]
    v_pk_add_f32 v[34:35], v[34:35], v[50:51]
    v_pk_add_f32 v[66:67], v[66:67], v[82:83]
    v_pk_add_f32 v[34:35], v[34:35], v[234:235]
    v_pk_add_f32 v[32:33], v[32:33], v[64:65]
    v_pk_add_f32 v[34:35], v[34:35], v[66:67]
    v_cvt_pk_bf16_f32 v96, v32, v33
    v_cvt_pk_bf16_f32 v97, v34, v35
    s_waitcnt lgkmcnt(8)
    v_pk_add_f32 v[36:37], v[36:37], v[52:53]
    v_pk_add_f32 v[68:69], v[68:69], v[84:85]
    v_pk_add_f32 v[36:37], v[36:37], v[236:237]
    v_pk_add_f32 v[38:39], v[38:39], v[54:55]
    v_pk_add_f32 v[70:71], v[70:71], v[86:87]
    v_pk_add_f32 v[38:39], v[38:39], v[238:239]
    v_pk_add_f32 v[36:37], v[36:37], v[68:69]
    v_pk_add_f32 v[38:39], v[38:39], v[70:71]
    v_cvt_pk_bf16_f32 v98, v36, v37
    v_cvt_pk_bf16_f32 v99, v38, v39
    buffer_store_dwordx4 v[96:99], v4, s[48:51], s61 offen
    s_waitcnt lgkmcnt(4)
    v_pk_add_f32 v[40:41], v[40:41], v[56:57]
    v_pk_add_f32 v[72:73], v[72:73], v[88:89]
    v_pk_add_f32 v[40:41], v[40:41], v[240:241]
    v_pk_add_f32 v[42:43], v[42:43], v[58:59]
    v_pk_add_f32 v[74:75], v[74:75], v[90:91]
    v_pk_add_f32 v[42:43], v[42:43], v[242:243]
    v_pk_add_f32 v[40:41], v[40:41], v[72:73]
    v_pk_add_f32 v[42:43], v[42:43], v[74:75]
    v_cvt_pk_bf16_f32 v100, v40, v41
    v_cvt_pk_bf16_f32 v101, v42, v43
    s_waitcnt lgkmcnt(0)
    v_pk_add_f32 v[44:45], v[44:45], v[60:61]
    v_pk_add_f32 v[76:77], v[76:77], v[92:93]
    v_pk_add_f32 v[44:45], v[44:45], v[244:245]
    v_pk_add_f32 v[46:47], v[46:47], v[62:63]
    v_pk_add_f32 v[78:79], v[78:79], v[94:95]
    v_pk_add_f32 v[46:47], v[46:47], v[246:247]
    v_pk_add_f32 v[44:45], v[44:45], v[76:77]
    v_pk_add_f32 v[46:47], v[46:47], v[78:79]
    v_cvt_pk_bf16_f32 v102, v44, v45
    v_cvt_pk_bf16_f32 v103, v46, v47
    buffer_store_dwordx4 v[100:103], v4, s[48:51], s79 offen
    s_endpgm
L_amid:
    s_setprio 2
    s_mov_b32 s32, s18
    s_mov_b32 s33, s19
    s_mov_b32 s34, 896
    s_mov_b32 s35, 0x20000
    s_xor_b32 s72, s69, 1
    s_lshr_b32 s70, s3, 1
    s_lshl1_add_u32 s70, s72, s70
    s_mul_i32 s61, s70, 28672
    s_and_b32 s71, s3, 1
    s_lshl1_add_u32 s71, s68, s71
    s_lshl_b32 s71, s71, 6
    s_add_u32 s61, s61, s71
    s_add_u32 s70, s61, 14336
    v_lshrrev_b32 v7, 2, v0
    v_and_b32 v6, 3, v0
    v_lshlrev_b32 v6, 4, v6
    v_mul_u32_u24 v4, 896, v7
    v_add_u32 v4, v4, v6
    buffer_load_dwordx4 v[96:99], v4, s[28:31], s61 offen
    buffer_load_dwordx4 v[100:103], v4, s[28:31], s70 offen
    buffer_load_dwordx4 v[104:107], v6, s[32:35], s71 offen
    s_barrier
    v_mul_u32_u24 v17, 68, v6
    v_lshl_add_u32 v17, v7, 4, v17
    s_add_u32 s70, s26, 23552
    v_add_u32 v17, s70, v17
    v_mov_b32 v8, 1
    s_xor_b32 s40, s2, 4
    s_lshl2_add_u32 s40, s40, s3
    s_lshl_b32 s40, s40, 11
    s_add_u32 s40, s40, 13631488
    s_lshl2_add_u32 s41, s72, s3
    s_lshl_b32 s41, s41, 7
    s_lshl2_add_u32 s41, s68, s41
    s_add_u32 s41, s41, 12058656
    s_waitcnt vmcnt(0)
    v_lshlrev_b32 v128, 16, v104
    v_and_b32 v129, s10, v104
    v_lshlrev_b32 v130, 16, v105
    v_and_b32 v131, s10, v105
    v_lshlrev_b32 v132, 16, v106
    v_and_b32 v133, s10, v106
    v_lshlrev_b32 v134, 16, v107
    v_and_b32 v135, s10, v107
    v_lshlrev_b32 v112, 16, v96
    v_and_b32 v113, s10, v96
    v_add_f32 v112, v112, v128
    v_add_f32 v113, v113, v129
    v_lshlrev_b32 v114, 16, v97
    v_and_b32 v115, s10, v97
    v_add_f32 v114, v114, v130
    v_add_f32 v115, v115, v131
    v_lshlrev_b32 v116, 16, v98
    v_and_b32 v117, s10, v98
    v_add_f32 v116, v116, v132
    v_add_f32 v117, v117, v133
    v_lshlrev_b32 v118, 16, v99
    v_and_b32 v119, s10, v99
    v_add_f32 v118, v118, v134
    v_add_f32 v119, v119, v135
    v_lshlrev_b32 v120, 16, v100
    v_and_b32 v121, s10, v100
    v_add_f32 v120, v120, v128
    v_add_f32 v121, v121, v129
    v_lshlrev_b32 v122, 16, v101
    v_and_b32 v123, s10, v101
    v_add_f32 v122, v122, v130
    v_add_f32 v123, v123, v131
    v_lshlrev_b32 v124, 16, v102
    v_and_b32 v125, s10, v102
    v_add_f32 v124, v124, v132
    v_add_f32 v125, v125, v133
    v_lshlrev_b32 v126, 16, v103
    v_and_b32 v127, s10, v103
    v_add_f32 v126, v126, v134
    v_add_f32 v127, v127, v135
    s_barrier
    ds_read_b128 v[32:35], v17 offset:0
    ds_read_b128 v[48:51], v17 offset:4352
    ds_read_b128 v[64:67], v17 offset:8704
    ds_read_b128 v[80:83], v17 offset:13056
    ds_read_b128 v[36:39], v17 offset:512
    ds_read_b128 v[52:55], v17 offset:4864
    ds_read_b128 v[68:71], v17 offset:9216
    ds_read_b128 v[84:87], v17 offset:13568
    ds_read_b128 v[40:43], v17 offset:256
    ds_read_b128 v[56:59], v17 offset:4608
    ds_read_b128 v[72:75], v17 offset:8960
    ds_read_b128 v[88:91], v17 offset:13312
    ds_read_b128 v[44:47], v17 offset:768
    ds_read_b128 v[60:63], v17 offset:5120
    ds_read_b128 v[76:79], v17 offset:9472
    ds_read_b128 v[92:95], v17 offset:13824
    s_waitcnt lgkmcnt(12)
    v_add_f32 v32, v32, v48
    v_add_f32 v64, v64, v80
    v_add_f32 v33, v33, v49
    v_add_f32 v65, v65, v81
    v_add_f32 v34, v34, v50
    v_add_f32 v66, v66, v82
    v_add_f32 v35, v35, v51
    v_add_f32 v67, v67, v83
    v_add_f32 v32, v32, v112
    v_add_f32 v33, v33, v113
    v_add_f32 v34, v34, v114
    v_add_f32 v35, v35, v115
    v_add_f32 v32, v32, v64
    v_add_f32 v33, v33, v65
    v_add_f32 v34, v34, v66
    v_add_f32 v35, v35, v67
    v_cvt_pk_bf16_f32 v96, v32, v33
    v_cvt_pk_bf16_f32 v97, v34, v35
    s_waitcnt lgkmcnt(8)
    v_add_f32 v36, v36, v52
    v_add_f32 v68, v68, v84
    v_add_f32 v37, v37, v53
    v_add_f32 v69, v69, v85
    v_add_f32 v38, v38, v54
    v_add_f32 v70, v70, v86
    v_add_f32 v39, v39, v55
    v_add_f32 v71, v71, v87
    v_add_f32 v36, v36, v116
    v_add_f32 v37, v37, v117
    v_add_f32 v38, v38, v118
    v_add_f32 v39, v39, v119
    v_add_f32 v36, v36, v68
    v_add_f32 v37, v37, v69
    v_add_f32 v38, v38, v70
    v_add_f32 v39, v39, v71
    v_cvt_pk_bf16_f32 v98, v36, v37
    v_cvt_pk_bf16_f32 v99, v38, v39
    buffer_store_dwordx4 v[96:99], v18, s[36:39], s40 offen offset:0 sc1
    s_waitcnt lgkmcnt(4)
    v_add_f32 v40, v40, v56
    v_add_f32 v72, v72, v88
    v_add_f32 v41, v41, v57
    v_add_f32 v73, v73, v89
    v_add_f32 v42, v42, v58
    v_add_f32 v74, v74, v90
    v_add_f32 v43, v43, v59
    v_add_f32 v75, v75, v91
    v_add_f32 v40, v40, v120
    v_add_f32 v41, v41, v121
    v_add_f32 v42, v42, v122
    v_add_f32 v43, v43, v123
    v_add_f32 v40, v40, v72
    v_add_f32 v41, v41, v73
    v_add_f32 v42, v42, v74
    v_add_f32 v43, v43, v75
    v_cvt_pk_bf16_f32 v100, v40, v41
    v_cvt_pk_bf16_f32 v101, v42, v43
    s_waitcnt lgkmcnt(0)
    v_add_f32 v44, v44, v60
    v_add_f32 v76, v76, v92
    v_add_f32 v45, v45, v61
    v_add_f32 v77, v77, v93
    v_add_f32 v46, v46, v62
    v_add_f32 v78, v78, v94
    v_add_f32 v47, v47, v63
    v_add_f32 v79, v79, v95
    v_add_f32 v44, v44, v124
    v_add_f32 v45, v45, v125
    v_add_f32 v46, v46, v126
    v_add_f32 v47, v47, v127
    v_add_f32 v44, v44, v76
    v_add_f32 v45, v45, v77
    v_add_f32 v46, v46, v78
    v_add_f32 v47, v47, v79
    v_cvt_pk_bf16_f32 v102, v44, v45
    v_cvt_pk_bf16_f32 v103, v46, v47
    buffer_store_dwordx4 v[100:103], v18, s[36:39], s40 offen offset:1024 sc1
    s_waitcnt vmcnt(0)
    buffer_store_dword v8, off, s[36:39], s41 sc1
L_fin:
L_end:
    s_endpgm
L_init:
    s_mov_b32 s36, s24
    s_mov_b32 s37, s25
    s_mov_b32 s38, 15728640
    s_mov_b32 s39, 0x20000
    v_mov_b32 v40, 0
    v_mov_b32 v41, 0
    v_mov_b32 v42, 0
    v_mov_b32 v43, 0
    v_lshlrev_b32 v44, 7, v0
    s_sub_u32 s71, s2, 252
    s_lshl2_add_u32 s71, s71, s3
    s_mul_i32 s70, s71, 4096
    s_add_u32 s70, s70, 12058624
    buffer_store_dwordx4 v[40:43], v18, s[36:39], s70 offen offset:0 sc1
    buffer_store_dwordx4 v[40:43], v18, s[36:39], s70 offen offset:1024 sc1
    buffer_store_dwordx4 v[40:43], v18, s[36:39], s70 offen offset:2048 sc1
    buffer_store_dwordx4 v[40:43], v18, s[36:39], s70 offen offset:3072 sc1
    s_branch L_noinit
L_go:
    s_sub_u32 s71, s2, 252
    s_lshl2_add_u32 s71, s71, s3
    s_lshl_b32 s71, s71, 2
    v_mov_b32 v45, 1
    v_mov_b32 v46, s71
    s_waitcnt vmcnt(0)
    global_store_dword v46, v45, s[8:9] sc1
    s_branch L_gone
L_red:
    s_lshr_b32 s72, s69, 3
    s_lshl2_add_u32 s71, s72, s3
    s_and_b32 s77, s3, 1
    s_cselect_b32 s44, -1, 0
    s_cselect_b32 s47, 0, -1
    s_mov_b32 s45, 0
    s_mov_b32 s46, 0
    s_mul_i32 s42, s71, 2048
    s_add_u32 s42, s42, 12091392
    v_and_b32 v1, 31, v0
    v_mul_u32_u24 v1, 64, v1
    s_lshl_b32 s71, s71, 15
    s_add_u32 s27, s71, 11534336
    s_waitcnt vmcnt(0)
    buffer_store_dword v16, off, s[36:39], s57 sc1
    s_lshr_b32 s72, s69, 3
    s_and_b32 s65, s69, 7
    s_lshl3_add_u32 s65, s65, s99
    s_lshl_b32 s77, s65, 7
    s_add_u32 s77, s77, 12075008
    s_add_u32 s58, s24, s77
    s_addc_u32 s59, s25, 0
    s_lshr_b32 s77, s65, 1
    s_lshl2_add_u32 s77, s77, s72
    s_lshl_b32 s77, s77, 7
    s_add_u32 s77, s77, 12058624
    s_and_b32 s71, s99, 1
    s_lshl2_add_u32 s77, s71, s77
    s_add_u32 s77, s77, 16
    v_mov_b32 v9, s77
    v_mov_b32 v8, 1
    s_mul_i32 s72, s72, 7168
    s_mul_i32 s4, s65, 28672
    s_add_u32 s4, s4, s72
    s_add_u32 s4, s4, 9437184
    s_add_u32 s5, s4, 4096
    s_mul_i32 s40, s65, 143360
    s_add_u32 s40, s40, s72
    s_add_u32 s40, s40, 114688
    s_add_u32 s41, s40, 4096
    s_mov_b32 s82, 0
    s_mov_b32 s83, -1
    s_mov_b32 s51, 0x358637bd
    v_add_u32 v12, 120832, v18
    v_add_u32 v11, 38912, v18
    v_add_u32 v13, s26, v18
    s_waitcnt lgkmcnt(0)
    v_bfe_u32 v2, v0, 3, 2
    v_bfe_u32 v3, v0, 1, 1
    v_lshl_add_u32 v2, v2, 1, v3
    s_mov_b32 vcc_lo, 0x0f0f0f0f
    s_mov_b32 vcc_hi, 0xf0f0f0f0
    v_cndmask_b32 v2, 63, v2, vcc
    s_mov_b32 vcc_lo, 0xaaaaaaaa
    s_mov_b32 vcc_hi, vcc_lo
    v_mov_b32 v3, 0x3f80
    v_mov_b32 v4, 0x3f800000
    v_cndmask_b32 v3, v3, v4, vcc
    v_cmp_eq_u32 vcc, 0, v2
    s_nop 1
    v_cndmask_b32 v184, 0, v3, vcc
    v_cmp_eq_u32 vcc, 1, v2
    s_nop 1
    v_cndmask_b32 v185, 0, v3, vcc
    v_cmp_eq_u32 vcc, 2, v2
    s_nop 1
    v_cndmask_b32 v186, 0, v3, vcc
    v_cmp_eq_u32 vcc, 3, v2
    s_nop 1
    v_cndmask_b32 v187, 0, v3, vcc
    v_cmp_eq_u32 vcc, 4, v2
    s_nop 1
    v_cndmask_b32 v188, 0, v3, vcc
    v_cmp_eq_u32 vcc, 5, v2
    s_nop 1
    v_cndmask_b32 v189, 0, v3, vcc
    v_cmp_eq_u32 vcc, 6, v2
    s_nop 1
    v_cndmask_b32 v190, 0, v3, vcc
    v_cmp_eq_u32 vcc, 7, v2
    s_nop 1
    v_cndmask_b32 v191, 0, v3, vcc
    v_and_b32 v1, 15, v0
    v_lshlrev_b32 v1, 1, v1
    v_bfe_u32 v2, v0, 4, 1
    v_add_u32 v1, v1, v2
    v_mul_u32_u24 v1, 64, v1
    v_add_u32 v15, 16384, v18
    s_mov_b32 s60, 0xffff
    s_mov_b32 s61, 0
    s_mov_b32 s77, 0
    s_waitcnt vmcnt(0)
    s_and_b32 s62, s60, s61
    s_cbranch_scc0 L_dyn0
L_dyr0:
    s_ff1_i32_b32 s63, s62
    s_bitset0_b32 s60, s63
    s_lshl_b32 s63, s63, 10
    s_add_u32 s63, s63, s27
    buffer_load_dwordx4 v[32:35], v18, s[36:39], s63 offen sc1
    buffer_load_dwordx4 v[36:39], v15, s[36:39], s63 offen sc1
    s_and_b32 s62, s60, s61
    s_cbranch_scc0 L_dyn1
L_dyr1:
    s_ff1_i32_b32 s63, s62
    s_bitset0_b32 s60, s63
    s_lshl_b32 s63, s63, 10
    s_add_u32 s63, s63, s27
    buffer_load_dwordx4 v[40:43], v18, s[36:39], s63 offen sc1
    buffer_load_dwordx4 v[44:47], v15, s[36:39], s63 offen sc1
    buffer_load_dword v14, v1, s[36:39], s42 offen sc1
    s_and_b32 s62, s60, s61
    s_cbranch_scc0 L_dyn2
L_dyr2:
    s_ff1_i32_b32 s63, s62
    s_bitset0_b32 s60, s63
    s_lshl_b32 s63, s63, 10
    s_add_u32 s63, s63, s27
    buffer_load_dwordx4 v[48:51], v18, s[36:39], s63 offen sc1
    buffer_load_dwordx4 v[52:55], v15, s[36:39], s63 offen sc1
    s_and_b32 s62, s60, s61
    s_cbranch_scc0 L_dyn3
L_dyr3:
    s_ff1_i32_b32 s63, s62
    s_bitset0_b32 s60, s63
    s_lshl_b32 s63, s63, 10
    s_add_u32 s63, s63, s27
    buffer_load_dwordx4 v[56:59], v18, s[36:39], s63 offen sc1
    buffer_load_dwordx4 v[60:63], v15, s[36:39], s63 offen sc1
    s_and_b32 s62, s60, s61
    s_cbranch_scc0 L_dyn4
L_dyr4:
    s_ff1_i32_b32 s63, s62
    s_bitset0_b32 s60, s63
    s_lshl_b32 s63, s63, 10
    s_add_u32 s63, s63, s27
    buffer_load_dwordx4 v[64:67], v18, s[36:39], s63 offen sc1
    buffer_load_dwordx4 v[68:71], v15, s[36:39], s63 offen sc1
    s_and_b32 s62, s60, s61
    s_cbranch_scc0 L_dyn5
L_dyr5:
    s_ff1_i32_b32 s63, s62
    s_bitset0_b32 s60, s63
    s_lshl_b32 s63, s63, 10
    s_add_u32 s63, s63, s27
    buffer_load_dwordx4 v[72:75], v18, s[36:39], s63 offen sc1
    s_waitcnt vmcnt(11)
    v_mfma_f32_32x32x16_bf16 v[160:175], v[184:187], v[32:35], 0
    buffer_load_dwordx4 v[76:79], v15, s[36:39], s63 offen sc1
    s_and_b32 s62, s60, s61
    s_cbranch_scc0 L_dyn6
L_dyr6:
    s_ff1_i32_b32 s63, s62
    s_bitset0_b32 s60, s63
    s_lshl_b32 s63, s63, 10
    s_add_u32 s63, s63, s27
    s_waitcnt vmcnt(11)
    v_mfma_f32_32x32x16_bf16 v[160:175], v[188:191], v[36:39], v[160:175]
    buffer_load_dwordx4 v[80:83], v18, s[36:39], s63 offen sc1
    s_waitcnt vmcnt(11)
    v_mfma_f32_32x32x16_bf16 v[160:175], v[184:187], v[40:43], v[160:175]
    buffer_load_dwordx4 v[84:87], v15, s[36:39], s63 offen sc1
    s_and_b32 s62, s60, s61
    s_cbranch_scc0 L_dyn7
L_dyr7:
    s_ff1_i32_b32 s63, s62
    s_bitset0_b32 s60, s63
    s_lshl_b32 s63, s63, 10
    s_add_u32 s63, s63, s27
    s_waitcnt vmcnt(11)
    v_mfma_f32_32x32x16_bf16 v[160:175], v[188:191], v[44:47], v[160:175]
    buffer_load_dwordx4 v[88:91], v18, s[36:39], s63 offen sc1
    s_waitcnt vmcnt(10)
    v_mfma_f32_32x32x16_bf16 v[160:175], v[184:187], v[48:51], v[160:175]
    buffer_load_dwordx4 v[92:95], v15, s[36:39], s63 offen sc1
    v_cmp_ne_u32 vcc, 0, v14
    s_nop 0
    s_lshr_b32 s62, vcc_lo, 16
    s_and_b32 s62, s62, vcc_lo
    s_or_b32 s61, s61, s62
    s_and_b32 s62, s60, s61
    s_cbranch_scc0 L_dyn8
L_dyr8:
    s_ff1_i32_b32 s63, s62
    s_bitset0_b32 s60, s63
    s_lshl_b32 s63, s63, 10
    s_add_u32 s63, s63, s27
    s_waitcnt vmcnt(10)
    v_mfma_f32_32x32x16_bf16 v[160:175], v[188:191], v[52:55], v[160:175]
    buffer_load_dwordx4 v[96:99], v18, s[36:39], s63 offen sc1
    s_waitcnt vmcnt(10)
    v_mfma_f32_32x32x16_bf16 v[160:175], v[184:187], v[56:59], v[160:175]
    buffer_load_dwordx4 v[100:103], v15, s[36:39], s63 offen sc1
    buffer_load_dword v14, v1, s[36:39], s42 offen sc1
    s_and_b32 s62, s60, s61
    s_cbranch_scc0 L_dyn9
L_dyr9:
    s_ff1_i32_b32 s63, s62
    s_bitset0_b32 s60, s63
    s_lshl_b32 s63, s63, 10
    s_add_u32 s63, s63, s27
    s_waitcnt vmcnt(11)
    v_mfma_f32_32x32x16_bf16 v[160:175], v[188:191], v[60:63], v[160:175]
    buffer_load_dwordx4 v[104:107], v18, s[36:39], s63 offen sc1
    s_waitcnt vmcnt(11)
    v_mfma_f32_32x32x16_bf16 v[160:175], v[184:187], v[64:67], v[160:175]
    buffer_load_dwordx4 v[108:111], v15, s[36:39], s63 offen sc1
    s_and_b32 s62, s60, s61
    s_cbranch_scc0 L_dyn10
L_dyr10:
    s_ff1_i32_b32 s63, s62
    s_bitset0_b32 s60, s63
    s_lshl_b32 s63, s63, 10
    s_add_u32 s63, s63, s27
    s_waitcnt vmcnt(11)
    v_mfma_f32_32x32x16_bf16 v[160:175], v[188:191], v[68:71], v[160:175]
    buffer_load_dwordx4 v[112:115], v18, s[36:39], s63 offen sc1
    s_waitcnt vmcnt(11)
    v_mfma_f32_32x32x16_bf16 v[160:175], v[184:187], v[72:75], v[160:175]
    buffer_load_dwordx4 v[116:119], v15, s[36:39], s63 offen sc1
    s_and_b32 s62, s60, s61
    s_cbranch_scc0 L_dyn11
L_dyr11:
    s_ff1_i32_b32 s63, s62
    s_bitset0_b32 s60, s63
    s_lshl_b32 s63, s63, 10
    s_add_u32 s63, s63, s27
    s_waitcnt vmcnt(11)
    v_mfma_f32_32x32x16_bf16 v[160:175], v[188:191], v[76:79], v[160:175]
    buffer_load_dwordx4 v[120:123], v18, s[36:39], s63 offen sc1
    s_waitcnt vmcnt(11)
    v_mfma_f32_32x32x16_bf16 v[160:175], v[184:187], v[80:83], v[160:175]
    buffer_load_dwordx4 v[124:127], v15, s[36:39], s63 offen sc1
    s_and_b32 s62, s60, s61
    s_cbranch_scc0 L_dyn12
L_dyr12:
    s_ff1_i32_b32 s63, s62
    s_bitset0_b32 s60, s63
    s_lshl_b32 s63, s63, 10
    s_add_u32 s63, s63, s27
    s_waitcnt vmcnt(11)
    v_mfma_f32_32x32x16_bf16 v[160:175], v[188:191], v[84:87], v[160:175]
    buffer_load_dwordx4 v[128:131], v18, s[36:39], s63 offen sc1
    s_waitcnt vmcnt(11)
    v_mfma_f32_32x32x16_bf16 v[160:175], v[184:187], v[88:91], v[160:175]
    buffer_load_dwordx4 v[132:135], v15, s[36:39], s63 offen sc1
    s_and_b32 s62, s60, s61
    s_cbranch_scc0 L_dyn13
L_dyr13:
    s_ff1_i32_b32 s63, s62
    s_bitset0_b32 s60, s63
    s_lshl_b32 s63, s63, 10
    s_add_u32 s63, s63, s27
    s_waitcnt vmcnt(11)
    v_mfma_f32_32x32x16_bf16 v[160:175], v[188:191], v[92:95], v[160:175]
    buffer_load_dwordx4 v[136:139], v18, s[36:39], s63 offen sc1
    s_waitcnt vmcnt(11)
    v_mfma_f32_32x32x16_bf16 v[160:175], v[184:187], v[96:99], v[160:175]
    buffer_load_dwordx4 v[140:143], v15, s[36:39], s63 offen sc1
    s_and_b32 s62, s60, s61
    s_cbranch_scc0 L_dyn14
L_dyr14:
    s_ff1_i32_b32 s63, s62
    s_bitset0_b32 s60, s63
    s_lshl_b32 s63, s63, 10
    s_add_u32 s63, s63, s27
    s_waitcnt vmcnt(11)
    v_mfma_f32_32x32x16_bf16 v[160:175], v[188:191], v[100:103], v[160:175]
    buffer_load_dwordx4 v[144:147], v18, s[36:39], s63 offen sc1
    s_waitcnt vmcnt(10)
    v_mfma_f32_32x32x16_bf16 v[160:175], v[184:187], v[104:107], v[160:175]
    buffer_load_dwordx4 v[148:151], v15, s[36:39], s63 offen sc1
    v_cmp_ne_u32 vcc, 0, v14
    s_nop 0
    s_lshr_b32 s62, vcc_lo, 16
    s_and_b32 s62, s62, vcc_lo
    s_or_b32 s61, s61, s62
    s_and_b32 s62, s60, s61
    s_cbranch_scc0 L_dyn15
L_dyr15:
    s_ff1_i32_b32 s63, s62
    s_bitset0_b32 s60, s63
    s_lshl_b32 s63, s63, 10
    s_add_u32 s63, s63, s27
    s_waitcnt vmcnt(10)
    v_mfma_f32_32x32x16_bf16 v[160:175], v[188:191], v[108:111], v[160:175]
    buffer_load_dwordx4 v[152:155], v18, s[36:39], s63 offen sc1
    s_waitcnt vmcnt(10)
    v_mfma_f32_32x32x16_bf16 v[160:175], v[184:187], v[112:115], v[160:175]
    buffer_load_dwordx4 v[156:159], v15, s[36:39], s63 offen sc1
    s_waitcnt vmcnt(10)
    v_mfma_f32_32x32x16_bf16 v[160:175], v[188:191], v[116:119], v[160:175]
    s_waitcnt vmcnt(9)
    v_mfma_f32_32x32x16_bf16 v[160:175], v[184:187], v[120:123], v[160:175]
    s_waitcnt vmcnt(8)
    v_mfma_f32_32x32x16_bf16 v[160:175], v[188:191], v[124:127], v[160:175]
    s_waitcnt vmcnt(7)
    v_mfma_f32_32x32x16_bf16 v[160:175], v[184:187], v[128:131], v[160:175]
    s_waitcnt vmcnt(6)
    v_mfma_f32_32x32x16_bf16 v[160:175], v[188:191], v[132:135], v[160:175]
    s_waitcnt vmcnt(5)
    v_mfma_f32_32x32x16_bf16 v[160:175], v[184:187], v[136:139], v[160:175]
    s_load_dwordx8 s[84:91], s[58:59], 0 glc
    s_waitcnt vmcnt(4)
    v_mfma_f32_32x32x16_bf16 v[160:175], v[188:191], v[140:143], v[160:175]
    s_waitcnt vmcnt(3)
    v_mfma_f32_32x32x16_bf16 v[160:175], v[184:187], v[144:147], v[160:175]
    s_waitcnt vmcnt(2)
    v_mfma_f32_32x32x16_bf16 v[160:175], v[188:191], v[148:151], v[160:175]
    s_waitcnt vmcnt(1)
    v_mfma_f32_32x32x16_bf16 v[160:175], v[184:187], v[152:155], v[160:175]
    s_waitcnt vmcnt(0)
    v_mfma_f32_32x32x16_bf16 v[160:175], v[188:191], v[156:159], v[160:175]
    s_nop 11
    v_cvt_pk_bf16_f32 v176, v160, v161
    v_cvt_pk_bf16_f32 v177, v162, v163
    v_cvt_pk_bf16_f32 v178, v164, v165
    v_cvt_pk_bf16_f32 v179, v166, v167
    v_cvt_pk_bf16_f32 v180, v168, v169
    v_cvt_pk_bf16_f32 v181, v170, v171
    v_cvt_pk_bf16_f32 v182, v172, v173
    v_cvt_pk_bf16_f32 v183, v174, v175
    v_cndmask_b32 v176, v176, 0, s[44:45]
    v_cndmask_b32 v177, v177, 0, s[44:45]
    v_cndmask_b32 v182, v182, 0, s[46:47]
    v_cndmask_b32 v183, v183, 0, s[46:47]
    ds_write_b128 v13, v[176:179] offset:38912
    ds_write_b128 v13, v[180:183] offset:39936
    s_branch L_join
L_gol_2:
    s_mov_b32 s84, 0
L_gol_2_l:
    s_sleep 8
    v_and_b32 v19, 15, v0
    v_lshlrev_b32 v19, 2, v19
    global_load_dword v19, v19, s[22:23] sc1
    s_waitcnt vmcnt(0)
    v_cmp_eq_u32 vcc, 0, v19
    s_cbranch_vccz L_go_1
    s_add_u32 s84, s84, 1
    s_cmp_lt_u32 s84, 40000
    s_cbranch_scc1 L_gol_2_l
    s_branch L_go_1
L_poll_3:
    s_mov_b32 s77, 0
L_poll_3_l:
    s_sleep 2
    s_load_dwordx4 s[84:87], s[14:15], 0 glc
    s_waitcnt lgkmcnt(0)
    s_and_b64 s[84:85], s[84:85], s[86:87]
    s_and_b32 s84, s84, s85
    s_and_b32 s84, s84, 1
    s_cbranch_scc1 L_pend_4
    s_add_u32 s77, s77, 1
    s_cmp_lt_u32 s77, 40000
    s_cbranch_scc1 L_poll_3_l
    s_branch L_pend_4
L_poll_5:
    s_mov_b32 s77, 0
L_poll_5_l:
    s_sleep 2
    s_load_dwordx4 s[84:87], s[14:15], 0 glc
    s_waitcnt lgkmcnt(0)
    s_and_b64 s[84:85], s[84:85], s[86:87]
    s_and_b32 s84, s84, s85
    s_and_b32 s84, s84, 2
    s_cbranch_scc1 L_pend_6
    s_add_u32 s77, s77, 1
    s_cmp_lt_u32 s77, 40000
    s_cbranch_scc1 L_poll_5_l
    s_branch L_pend_6
L_poll_7:
    s_mov_b32 s77, 0
L_poll_7_l:
    s_sleep 2
    s_load_dwordx4 s[84:87], s[14:15], 0 glc
    s_waitcnt lgkmcnt(0)
    s_and_b64 s[84:85], s[84:85], s[86:87]
    s_and_b32 s84, s84, s85
    s_and_b32 s84, s84, 4
    s_cbranch_scc1 L_pend_8
    s_add_u32 s77, s77, 1
    s_cmp_lt_u32 s77, 40000
    s_cbranch_scc1 L_poll_7_l
    s_branch L_pend_8
L_poll_9:
    s_mov_b32 s77, 0
L_poll_9_l:
    s_sleep 2
    s_load_dwordx4 s[84:87], s[14:15], 0 glc
    s_waitcnt lgkmcnt(0)
    s_and_b64 s[84:85], s[84:85], s[86:87]
    s_and_b32 s84, s84, s85
    s_and_b32 s84, s84, 8
    s_cbranch_scc1 L_pend_10
    s_add_u32 s77, s77, 1
    s_cmp_lt_u32 s77, 40000
    s_cbranch_scc1 L_poll_9_l
    s_branch L_pend_10
L_poll_11:
    s_mov_b32 s77, 0
L_poll_11_l:
    s_sleep 2
    s_load_dwordx4 s[84:87], s[92:93], 0 glc
    s_waitcnt lgkmcnt(0)
    s_and_b64 s[84:85], s[84:85], s[86:87]
    s_and_b32 s84, s84, s85
    s_and_b32 s84, s84, 8
    s_cbranch_scc1 L_pend_12
    s_add_u32 s77, s77, 1
    s_cmp_lt_u32 s77, 40000
    s_cbranch_scc1 L_poll_11_l
    s_branch L_pend_12
L_poll_13:
    s_mov_b32 s77, 0
L_poll_13_l:
    s_sleep 2
    s_load_dwordx2 s[84:85], s[14:15], 16 glc
    s_waitcnt lgkmcnt(0)
    s_and_b32 s84, s84, s85
    s_and_b32 s84, s84, 1
    s_cbranch_scc1 L_pend_14
    s_add_u32 s77, s77, 1
    s_cmp_lt_u32 s77, 40000
    s_cbranch_scc1 L_poll_13_l
    s_branch L_pend_14
L_poll_15:
    s_mov_b32 s77, 0
L_poll_15_l:
    s_sleep 2
    s_load_dword s84, s[14:15], s22 glc
    s_waitcnt lgkmcnt(0)
    s_and_b32 s84, s84, 1
    s_cbranch_scc1 L_pend_16
    s_add_u32 s77, s77, 1
    s_cmp_lt_u32 s77, 40000
    s_cbranch_scc1 L_poll_15_l
    s_branch L_pend_16
L_gol_18:
    s_mov_b32 s84, 0
L_gol_18_l:
    s_sleep 8
    v_and_b32 v19, 15, v0
    v_lshlrev_b32 v19, 2, v19
    global_load_dword v19, v19, s[22:23] sc1
    s_waitcnt vmcnt(0)
    v_cmp_eq_u32 vcc, 0, v19
    s_cbranch_vccz L_go_17
    s_add_u32 s84, s84, 1
    s_cmp_lt_u32 s84, 40000
    s_cbranch_scc1 L_gol_18_l
    s_branch L_go_17
L_dyn0:
    buffer_load_dword v14, v1, s[36:39], s42 offen sc1
    s_waitcnt vmcnt(0)
    v_cmp_ne_u32 vcc, 0, v14
    s_nop 0
    s_lshr_b32 s62, vcc_lo, 16
    s_and_b32 s62, s62, vcc_lo
    s_or_b32 s61, s61, s62
    s_and_b32 s62, s60, s61
    s_cbranch_scc1 L_dyr0
    s_add_u32 s77, s77, 1
    s_cmp_lt_u32 s77, 40000
    s_cbranch_scc1 L_dyn0
    s_mov_b32 s61, 0xffff
    s_mov_b32 s62, s60
    s_branch L_dyr0
L_dyn1:
    s_sleep 3
    buffer_load_dword v14, v1, s[36:39], s42 offen sc1
    s_waitcnt vmcnt(0)
    v_cmp_ne_u32 vcc, 0, v14
    s_nop 0
    s_lshr_b32 s62, vcc_lo, 16
    s_and_b32 s62, s62, vcc_lo
    s_or_b32 s61, s61, s62
    s_and_b32 s62, s60, s61
    s_cbranch_scc1 L_dyr1
    s_add_u32 s77, s77, 1
    s_cmp_lt_u32 s77, 40000
    s_cbranch_scc1 L_dyn1
    s_mov_b32 s61, 0xffff
    s_mov_b32 s62, s60
    s_branch L_dyr1
L_dyn2:
    s_sleep 3
    buffer_load_dword v14, v1, s[36:39], s42 offen sc1
    s_waitcnt vmcnt(0)
    v_cmp_ne_u32 vcc, 0, v14
    s_nop 0
    s_lshr_b32 s62, vcc_lo, 16
    s_and_b32 s62, s62, vcc_lo
    s_or_b32 s61, s61, s62
    s_and_b32 s62, s60, s61
    s_cbranch_scc1 L_dyr2
    s_add_u32 s77, s77, 1
    s_cmp_lt_u32 s77, 40000
    s_cbranch_scc1 L_dyn2
    s_mov_b32 s61, 0xffff
    s_mov_b32 s62, s60
    s_branch L_dyr2
L_dyn3:
    s_sleep 3
    buffer_load_dword v14, v1, s[36:39], s42 offen sc1
    s_waitcnt vmcnt(0)
    v_cmp_ne_u32 vcc, 0, v14
    s_nop 0
    s_lshr_b32 s62, vcc_lo, 16
    s_and_b32 s62, s62, vcc_lo
    s_or_b32 s61, s61, s62
    s_and_b32 s62, s60, s61
    s_cbranch_scc1 L_dyr3
    s_add_u32 s77, s77, 1
    s_cmp_lt_u32 s77, 40000
    s_cbranch_scc1 L_dyn3
    s_mov_b32 s61, 0xffff
    s_mov_b32 s62, s60
    s_branch L_dyr3
L_dyn4:
    s_sleep 3
    buffer_load_dword v14, v1, s[36:39], s42 offen sc1
    s_waitcnt vmcnt(0)
    v_cmp_ne_u32 vcc, 0, v14
    s_nop 0
    s_lshr_b32 s62, vcc_lo, 16
    s_and_b32 s62, s62, vcc_lo
    s_or_b32 s61, s61, s62
    s_and_b32 s62, s60, s61
    s_cbranch_scc1 L_dyr4
    s_add_u32 s77, s77, 1
    s_cmp_lt_u32 s77, 40000
    s_cbranch_scc1 L_dyn4
    s_mov_b32 s61, 0xffff
    s_mov_b32 s62, s60
    s_branch L_dyr4
L_dyn5:
    s_sleep 3
    buffer_load_dword v14, v1, s[36:39], s42 offen sc1
    s_waitcnt vmcnt(0)
    v_cmp_ne_u32 vcc, 0, v14
    s_nop 0
    s_lshr_b32 s62, vcc_lo, 16
    s_and_b32 s62, s62, vcc_lo
    s_or_b32 s61, s61, s62
    s_and_b32 s62, s60, s61
    s_cbranch_scc1 L_dyr5
    s_add_u32 s77, s77, 1
    s_cmp_lt_u32 s77, 40000
    s_cbranch_scc1 L_dyn5
    s_mov_b32 s61, 0xffff
    s_mov_b32 s62, s60
    s_branch L_dyr5
L_dyn6:
    s_sleep 3
    buffer_load_dword v14, v1, s[36:39], s42 offen sc1
    s_waitcnt vmcnt(0)
    v_cmp_ne_u32 vcc, 0, v14
    s_nop 0
    s_lshr_b32 s62, vcc_lo, 16
    s_and_b32 s62, s62, vcc_lo
    s_or_b32 s61, s61, s62
    s_and_b32 s62, s60, s61
    s_cbranch_scc1 L_dyr6
    s_add_u32 s77, s77, 1
    s_cmp_lt_u32 s77, 40000
    s_cbranch_scc1 L_dyn6
    s_mov_b32 s61, 0xffff
    s_mov_b32 s62, s60
    s_branch L_dyr6
L_dyn7:
    s_sleep 3
    buffer_load_dword v14, v1, s[36:39], s42 offen sc1
    s_waitcnt vmcnt(0)
    v_cmp_ne_u32 vcc, 0, v14
    s_nop 0
    s_lshr_b32 s62, vcc_lo, 16
    s_and_b32 s62, s62, vcc_lo
    s_or_b32 s61, s61, s62
    s_and_b32 s62, s60, s61
    s_cbranch_scc1 L_dyr7
    s_add_u32 s77, s77, 1
    s_cmp_lt_u32 s77, 40000
    s_cbranch_scc1 L_dyn7
    s_mov_b32 s61, 0xffff
    s_mov_b32 s62, s60
    s_branch L_dyr7
L_dyn8:
    s_sleep 3
    buffer_load_dword v14, v1, s[36:39], s42 offen sc1
    s_waitcnt vmcnt(0)
    v_cmp_ne_u32 vcc, 0, v14
    s_nop 0
    s_lshr_b32 s62, vcc_lo, 16
    s_and_b32 s62, s62, vcc_lo
    s_or_b32 s61, s61, s62
    s_and_b32 s62, s60, s61
    s_cbranch_scc1 L_dyr8
    s_add_u32 s77, s77, 1
    s_cmp_lt_u32 s77, 40000
    s_cbranch_scc1 L_dyn8
    s_mov_b32 s61, 0xffff
    s_mov_b32 s62, s60
    s_branch L_dyr8
L_dyn9:
    s_sleep 3
    buffer_load_dword v14, v1, s[36:39], s42 offen sc1
    s_waitcnt vmcnt(0)
    v_cmp_ne_u32 vcc, 0, v14
    s_nop 0
    s_lshr_b32 s62, vcc_lo, 16
    s_and_b32 s62, s62, vcc_lo
    s_or_b32 s61, s61, s62
    s_and_b32 s62, s60, s61
    s_cbranch_scc1 L_dyr9
    s_add_u32 s77, s77, 1
    s_cmp_lt_u32 s77, 40000
    s_cbranch_scc1 L_dyn9
    s_mov_b32 s61, 0xffff
    s_mov_b32 s62, s60
    s_branch L_dyr9
L_dyn10:
    s_sleep 3
    buffer_load_dword v14, v1, s[36:39], s42 offen sc1
    s_waitcnt vmcnt(0)
    v_cmp_ne_u32 vcc, 0, v14
    s_nop 0
    s_lshr_b32 s62, vcc_lo, 16
    s_and_b32 s62, s62, vcc_lo
    s_or_b32 s61, s61, s62
    s_and_b32 s62, s60, s61
    s_cbranch_scc1 L_dyr10
    s_add_u32 s77, s77, 1
    s_cmp_lt_u32 s77, 40000
    s_cbranch_scc1 L_dyn10
    s_mov_b32 s61, 0xffff
    s_mov_b32 s62, s60
    s_branch L_dyr10
L_dyn11:
    s_sleep 3
    buffer_load_dword v14, v1, s[36:39], s42 offen sc1
    s_waitcnt vmcnt(0)
    v_cmp_ne_u32 vcc, 0, v14
    s_nop 0
    s_lshr_b32 s62, vcc_lo, 16
    s_and_b32 s62, s62, vcc_lo
    s_or_b32 s61, s61, s62
    s_and_b32 s62, s60, s61
    s_cbranch_scc1 L_dyr11
    s_add_u32 s77, s77, 1
    s_cmp_lt_u32 s77, 40000
    s_cbranch_scc1 L_dyn11
    s_mov_b32 s61, 0xffff
    s_mov_b32 s62, s60
    s_branch L_dyr11
L_dyn12:
    s_sleep 3
    buffer_load_dword v14, v1, s[36:39], s42 offen sc1
    s_waitcnt vmcnt(0)
    v_cmp_ne_u32 vcc, 0, v14
    s_nop 0
    s_lshr_b32 s62, vcc_lo, 16
    s_and_b32 s62, s62, vcc_lo
    s_or_b32 s61, s61, s62
    s_and_b32 s62, s60, s61
    s_cbranch_scc1 L_dyr12
    s_add_u32 s77, s77, 1
    s_cmp_lt_u32 s77, 40000
    s_cbranch_scc1 L_dyn12
    s_mov_b32 s61, 0xffff
    s_mov_b32 s62, s60
    s_branch L_dyr12
L_dyn13:
    s_sleep 3
    buffer_load_dword v14, v1, s[36:39], s42 offen sc1
    s_waitcnt vmcnt(0)
    v_cmp_ne_u32 vcc, 0, v14
    s_nop 0
    s_lshr_b32 s62, vcc_lo, 16
    s_and_b32 s62, s62, vcc_lo
    s_or_b32 s61, s61, s62
    s_and_b32 s62, s60, s61
    s_cbranch_scc1 L_dyr13
    s_add_u32 s77, s77, 1
    s_cmp_lt_u32 s77, 40000
    s_cbranch_scc1 L_dyn13
    s_mov_b32 s61, 0xffff
    s_mov_b32 s62, s60
    s_branch L_dyr13
L_dyn14:
    s_sleep 3
    buffer_load_dword v14, v1, s[36:39], s42 offen sc1
    s_waitcnt vmcnt(0)
    v_cmp_ne_u32 vcc, 0, v14
    s_nop 0
    s_lshr_b32 s62, vcc_lo, 16
    s_and_b32 s62, s62, vcc_lo
    s_or_b32 s61, s61, s62
    s_and_b32 s62, s60, s61
    s_cbranch_scc1 L_dyr14
    s_add_u32 s77, s77, 1
    s_cmp_lt_u32 s77, 40000
    s_cbranch_scc1 L_dyn14
    s_mov_b32 s61, 0xffff
    s_mov_b32 s62, s60
    s_branch L_dyr14
L_dyn15:
    s_sleep 3
    buffer_load_dword v14, v1, s[36:39], s42 offen sc1
    s_waitcnt vmcnt(0)
    v_cmp_ne_u32 vcc, 0, v14
    s_nop 0
    s_lshr_b32 s62, vcc_lo, 16
    s_and_b32 s62, s62, vcc_lo
    s_or_b32 s61, s61, s62
    s_and_b32 s62, s60, s61
    s_cbranch_scc1 L_dyr15
    s_add_u32 s77, s77, 1
    s_cmp_lt_u32 s77, 40000
    s_cbranch_scc1 L_dyn15
    s_mov_b32 s61, 0xffff
    s_mov_b32 s62, s60
    s_branch L_dyr15
L_poll_19:
    s_mov_b32 s77, 0
L_poll_19_l:
    s_sleep 2
    s_load_dwordx8 s[84:91], s[58:59], 0 glc
    s_waitcnt lgkmcnt(0)
    s_and_b64 s[84:85], s[84:85], s[90:91]
    s_and_b64 s[84:85], s[84:85], s[88:89]
    s_and_b64 s[84:85], s[84:85], s[86:87]
    s_and_b32 s84, s84, s85
    s_and_b32 s84, s84, 1
    s_cbranch_scc1 L_pend_20
    s_add_u32 s77, s77, 1
    s_cmp_lt_u32 s77, 40000
    s_cbranch_scc1 L_poll_19_l
    s_branch L_pend_20
L_poll_21:
    s_mov_b32 s77, 0
L_poll_21_l:
    s_sleep 2
    s_load_dwordx4 s[84:87], s[14:15], 0 glc
    s_waitcnt lgkmcnt(0)
    s_and_b64 s[84:85], s[84:85], s[86:87]
    s_and_b32 s84, s84, s85
    s_and_b32 s84, s84, 1
    s_cbranch_scc1 L_pend_22
    s_add_u32 s77, s77, 1
    s_cmp_lt_u32 s77, 40000
    s_cbranch_scc1 L_poll_21_l
    s_branch L_pend_22
L_poll_23:
    s_mov_b32 s77, 0
L_poll_23_l:
    s_sleep 2
    s_load_dwordx4 s[84:87], s[14:15], 0 glc
    s_waitcnt lgkmcnt(0)
    s_and_b64 s[84:85], s[84:85], s[86:87]
    s_and_b32 s84, s84, s85
    s_and_b32 s84, s84, 2
    s_cbranch_scc1 L_pend_24
    s_add_u32 s77, s77, 1
    s_cmp_lt_u32 s77, 40000
    s_cbranch_scc1 L_poll_23_l
    s_branch L_pend_24
L_poll_25:
    s_mov_b32 s77, 0
L_poll_25_l:
    s_sleep 2
    s_load_dwordx4 s[84:87], s[14:15], 0 glc
    s_waitcnt lgkmcnt(0)
    s_and_b64 s[84:85], s[84:85], s[86:87]
    s_and_b32 s84, s84, s85
    s_and_b32 s84, s84, 4
    s_cbranch_scc1 L_pend_26
    s_add_u32 s77, s77, 1
    s_cmp_lt_u32 s77, 40000
    s_cbranch_scc1 L_poll_25_l
    s_branch L_pend_26
L_poll_27:
    s_mov_b32 s77, 0
L_poll_27_l:
    s_sleep 2
    s_load_dwordx4 s[84:87], s[14:15], 0 glc
    s_waitcnt lgkmcnt(0)
    s_and_b64 s[84:85], s[84:85], s[86:87]
    s_and_b32 s84, s84, s85
    s_and_b32 s84, s84, 8
    s_cbranch_scc1 L_pend_28
    s_add_u32 s77, s77, 1
    s_cmp_lt_u32 s77, 40000
    s_cbranch_scc1 L_poll_27_l
    s_branch L_pend_28
L_poll_29:
    s_mov_b32 s77, 0
L_poll_29_l:
    s_sleep 2
    s_load_dwordx4 s[84:87], s[92:93], 0 glc
    s_waitcnt lgkmcnt(0)
    s_and_b64 s[84:85], s[84:85], s[86:87]
    s_and_b32 s84, s84, s85
    s_and_b32 s84, s84, 8
    s_cbranch_scc1 L_pend_30
    s_add_u32 s77, s77, 1
    s_cmp_lt_u32 s77, 40000
    s_cbranch_scc1 L_poll_29_l
    s_branch L_pend_30
L_poll_31:
    s_mov_b32 s77, 0
L_poll_31_l:
    s_sleep 2
    s_load_dwordx2 s[84:85], s[14:15], 16 glc
    s_waitcnt lgkmcnt(0)
    s_and_b32 s84, s84, s85
    s_and_b32 s84, s84, 1
    s_cbranch_scc1 L_pend_32
    s_add_u32 s77, s77, 1
    s_cmp_lt_u32 s77, 40000
    s_cbranch_scc1 L_poll_31_l
    s_branch L_pend_32
L_poll_33:
    s_mov_b32 s77, 0
L_poll_33_l:
    s_sleep 2
    s_load_dword s84, s[14:15], s22 glc
    s_waitcnt lgkmcnt(0)
    s_and_b32 s84, s84, 1
    s_cbranch_scc1 L_pend_34
    s_add_u32 s77, s77, 1
    s_cmp_lt_u32 s77, 40000
    s_cbranch_scc1 L_poll_33_l
    s_branch L_pend_34
L_last:
    s_endpgm
.section .rodata,"a"
.p2align 6
.amdhsa_kernel parallel_sum__linear_attn_block__dense_activation_squared_relu__prompt_kernel
  .amdhsa_next_free_vgpr 256
  .amdhsa_next_free_sgpr 102
  .amdhsa_accum_offset 256
  .amdhsa_group_segment_fixed_size 0
  .amdhsa_kernarg_size 88
  .amdhsa_user_sgpr_count 2
  .amdhsa_user_sgpr_kernarg_segment_ptr 1
  .amdhsa_system_sgpr_workgroup_id_x 1
  .amdhsa_float_denorm_mode_32 3
.end_amdhsa_kernel
```
